```python
import torch

def _softmax(x, axis=-1):
    return torch.softmax(x, dim=axis)
def _gelu(x):
    return torch.nn.functional.gelu(x, approximate="tanh")
def _silu(x):
    return torch.nn.functional.silu(x)
def _sigmoid(x):
    return torch.sigmoid(x)
def _layernorm(x, axis=-1, eps=1e-5):
    m = x.mean(dim=axis, keepdim=True)
    v = x.var(dim=axis, keepdim=True, unbiased=False)
    return (x - m) / torch.sqrt(v + eps)
def _scatter_add(tgt, idx, src, axis=0):
    return tgt.clone().index_add_(axis, idx, src)
def _segment_sum(src, seg, n):
    out = torch.zeros((n,) + src.shape[1:], dtype=src.dtype)
    return out.index_add_(0, seg, src)
def _pad(x, pw):
    flat = tuple(v for pair in reversed(pw) for v in pair)
    return torch.nn.functional.pad(x, flat)

kernel_name = 'sequential_preLN__ssm_conv_h3__glu_gated_geglu__prompt'

def setup_inputs():

    _w = (lambda a: (lambda t: t.to(torch.bfloat16) if t.is_floating_point() else t)(torch.as_tensor(a)))
    def _A_setup():
        B, S, D = 1, 2048, 512
        ks = 4
        return {
            "q": _w((lambda *s: torch.randn(*s, dtype=torch.bfloat16) * 0.05)(B, S, D)),
            "k": _w((lambda *s: torch.randn(*s, dtype=torch.bfloat16) * 0.2)(B, S, D)),
            "v": _w((lambda *s: torch.randn(*s, dtype=torch.bfloat16) * 0.2)(B, S, D)),
            "shift_k": _w((lambda *s: torch.randn(*s, dtype=torch.bfloat16) * 0.2)(D, ks) * 0.5),
            "ssm_k": _w((lambda *s: torch.randn(*s, dtype=torch.bfloat16) * 0.4)(D, S) * (1.0 / S ** 0.5)),
            "ssm_D": _w((lambda *s: torch.randn(*s, dtype=torch.bfloat16) * 0.2)(D)),
        }
    _A_in = _A_setup()

    def _B_setup():
        B, S, Dm, Df = 1, 2048, 512, 1792
        return {
            "x": _w((lambda *s: torch.randn(*s, dtype=torch.bfloat16) * 0.05)(B, S, Dm)),
            "w_gate": _w((lambda *s: torch.randn(*s, dtype=torch.bfloat16) * 0.4)(Dm, Df) * (Dm ** -0.5)),
            "w_up": _w((lambda *s: torch.randn(*s, dtype=torch.bfloat16) * 0.4)(Dm, Df) * (Dm ** -0.5)),
            "w_down": _w((lambda *s: torch.randn(*s, dtype=torch.bfloat16) * 0.4)(Df, Dm) * (Df ** -0.5)),
        }
    _B_in = _B_setup()

    return {
        "A_q": _A_in["q"],
        "A_k": _A_in["k"],
        "A_v": _A_in["v"],
        "A_shift_k": _A_in["shift_k"],
        "A_ssm_k": _A_in["ssm_k"],
        "A_ssm_D": _A_in["ssm_D"],
        "B_x": _B_in["x"],
        "B_w_gate": _B_in["w_gate"],
        "B_w_up": _B_in["w_up"],
        "B_w_down": _B_in["w_down"],
    }

def reference(A_q, A_k, A_v, A_shift_k, A_ssm_k, A_ssm_D, B_x, B_w_gate, B_w_up, B_w_down):
    def _A_ref(q, k, v, shift_k, ssm_k, ssm_D):
        B, S, D = q.shape
        ks = shift_k.shape[-1]
        k_pad = _pad(k, ((0, 0), (ks - 1, 0), (0, 0)))
        k_shift = torch.zeros_like(k)
        for t in range(ks):
            k_shift = k_shift + k_pad[:, t:t + S, :] * shift_k[:, ks - 1 - t][None, None, :]
        kv = k_shift * v
        L = 2 * S
        kv_pad = _pad(kv, ((0, 0), (0, S), (0, 0)))
        kf_pad = _pad(ssm_k, ((0, 0), (0, S)))
        kv_f = (lambda x, axes=(-2,-1): torch.fft.rfft2(x.float(), dim=axes))(kv_pad[:, None, :, :], axes=(1, 2))
        kf_f = (lambda x, axes=(-2,-1): torch.fft.rfft2(x.float(), dim=axes))(kf_pad[:, None, :], axes=(1, 2))
        kf_f = (lambda x, *d: x.permute(*d))(kf_f, 1, 2, 0)
        y_f = kv_f * kf_f[None, :, :, :]
        y = (lambda x, s, axes=(-2,-1): torch.fft.irfft2(x, s=s, dim=axes).to(torch.bfloat16))(y_f, (1, L), axes=(1, 2))[:, 0, :S, :]
        y = y + kv * ssm_D[None, None, :]
        return q * y

    def _B_ref(x, w_gate, w_up, w_down):
        g = torch.einsum("bsd,df->bsf", x, w_gate)
        u = torch.einsum("bsd,df->bsf", x, w_up)
        h = _gelu(g) * u
        return torch.einsum("bsf,fd->bsd", h, w_down)

    x = A_q
    h = x + _A_ref(_layernorm(x, axis=-1), A_k, A_v, A_shift_k, A_ssm_k, A_ssm_D)
    h2 = h + _B_ref(_layernorm(h, axis=-1), B_w_gate, B_w_up, B_w_down)
    return h2
```

```asm
; @launch grid=(256,1,1) block=(256,1,1) lds=163840
.amdgcn_target "amdgcn-amd-amdhsa--gfx950"
.text
.globl sequential_preLN__ssm_conv_h3__glu_gated_geglu__prompt_kernel
.p2align 8
.type sequential_preLN__ssm_conv_h3__glu_gated_geglu__prompt_kernel,@function
sequential_preLN__ssm_conv_h3__glu_gated_geglu__prompt_kernel:
  s_cmp_ge_u32 s2, 256
  s_cbranch_scc1 L_end
  s_load_dwordx16 s[64:79], s[0:1], 0
  s_load_dwordx8 s[80:87], s[0:1], 64
  s_load_dwordx2 s[44:45], s[0:1], 96
  s_getpc_b64 s[56:57]
L_pc:
  s_sub_u32 s3, s2, 8
  s_cmp_ge_u32 s3, 16
  s_cbranch_scc1 L_nopf
  v_lshlrev_b32 v11, 7, v0
  v_min_u32 v11, L_codeend-L_pc-4, v11
  global_load_dword v245, v11, s[56:57]
L_nopf:
  v_and_b32 v255, 63, v0
  v_lshrrev_b32 v1, 6, v0
  s_and_b32 s51, s2, 7
  s_lshr_b32 s52, s2, 3
  v_readfirstlane_b32 s50, v1
  s_mov_b32 s10, 0x200000
  s_mov_b32 s11, 0x20000
  s_mov_b32 s14, s10
  s_mov_b32 s15, s11
  v_lshrrev_b32 v2, 3, v255
  v_and_b32 v3, 7, v255
  v_lshlrev_b32 v4, 10, v2
  v_lshl_add_u32 v4, v3, 4, v4
  s_lshl_b32 s56, s52, 16
  s_lshl_b32 s57, s51, 7
  s_add_u32 s56, s56, s57
  s_lshl_b32 s58, s50, 1
  s_sub_u32 s59, s56, 8192
  v_add_u32 v5, s59, v4
  s_add_u32 s59, s58, 0
  s_lshl_b32 s88, s59, 13
  s_add_u32 s88, s88, s56
  s_lshl_b32 s89, s59, 4
  s_add_u32 s90, s59, 1
  s_and_b32 s90, s90, 7
  s_lshl_b32 s90, s90, 4
  v_xor_b32 v6, s90, v4
  v_xor_b32 v8, s89, v4
  v_add_u32 v6, s88, v6
  v_add_u32 v8, s88, v8
  s_add_u32 s59, s58, 1
  s_lshl_b32 s88, s59, 13
  s_add_u32 s88, s88, s56
  s_lshl_b32 s89, s59, 4
  s_add_u32 s90, s59, 1
  s_and_b32 s90, s90, 7
  s_lshl_b32 s90, s90, 4
  v_xor_b32 v7, s90, v4
  v_xor_b32 v9, s89, v4
  v_add_u32 v7, s88, v7
  v_add_u32 v9, s88, v9
  s_lshl_b32 s91, s58, 10
  s_mov_b32 m0, 114944
  s_waitcnt lgkmcnt(0)
  s_mov_b64 s[8:9], s[66:67]
  s_mov_b64 s[12:13], s[68:69]
  buffer_load_dwordx4 v5, s[8:11], 0 offen lds
  s_add_u32 m0, s91, 115968
  s_nop 0
  buffer_load_dwordx4 v6, s[8:11], 0 offen lds
  s_add_u32 m0, s91, 116992
  s_nop 0
  buffer_load_dwordx4 v7, s[8:11], 0 offen lds
  s_add_u32 m0, s91, 124160
  s_nop 0
  buffer_load_dwordx4 v8, s[12:15], 0 offen lds
  s_add_u32 m0, s91, 125184
  s_nop 0
  buffer_load_dwordx4 v9, s[12:15], 0 offen lds
  s_mov_b64 s[16:17], s[70:71]
  s_mov_b32 s18, 4096
  s_mov_b32 s19, s11
  s_lshl_b32 s88, s51, 9
  s_lshl_b32 s89, s50, 7
  s_add_u32 s88, s88, s89
  v_lshl_add_u32 v10, v2, 4, s88
  buffer_load_dwordx4 v[12:15], v10, s[16:19], 0 offen
  s_mov_b64 s[4:5], s[64:65]
  s_mov_b32 s6, s10
  s_mov_b32 s7, s11
  s_add_u32 m0, s91, 132352
  s_nop 0
  buffer_load_dwordx4 v8, s[4:7], 0 offen lds
  s_add_u32 m0, s91, 133376
  s_nop 0
  buffer_load_dwordx4 v9, s[4:7], 0 offen lds
  s_mov_b64 s[20:21], s[72:73]
  s_mov_b64 s[24:25], s[74:75]
  s_mov_b64 s[28:29], s[78:79]
  s_mov_b64 s[32:33], s[80:81]
  s_mov_b64 s[36:37], s[82:83]
  s_mov_b64 s[40:41], s[84:85]
  s_mov_b64 s[48:49], s[86:87]
  s_mov_b32 s26, 1024
  s_mov_b32 s30, 1835008
  s_mov_b32 s46, 17825792
  s_mov_b32 s22, s10
  s_mov_b32 s42, s10
  s_mov_b32 s34, s30
  s_mov_b32 s38, s30
  s_mov_b32 s23, s11
  s_mov_b32 s27, s11
  s_mov_b32 s31, s11
  s_mov_b32 s35, s11
  s_mov_b32 s39, s11
  s_mov_b32 s43, s11
  s_mov_b32 s47, s11
  s_mov_b32 s96, 0x05040100
  s_mov_b32 s97, 0x07060302
  v_mov_b32 v243, v0
  s_or_b32 s3, s2, s50
  s_cmp_lg_u32 s3, 0
  s_cbranch_scc1 L_non_1
  s_memrealtime s[54:55]
  v_mov_b32 v17, 0
  s_waitcnt lgkmcnt(0)
  s_or_b32 s54, s54, 1
  v_mov_b32 v18, s54
  v_mov_b32 v19, s55
  s_mov_b64 exec, 1
  global_store_dwordx2 v17, v[18:19], s[48:49] sc1
  s_mov_b64 exec, -1
L_non_1:
  v_lshlrev_b32 v17, 4, v255
  s_lshl_b32 s64, s2, 13
  s_lshl_b32 s65, s50, 11
  s_add_u32 s64, s64, s65
  buffer_load_dwordx4 v[96:99], v17, s[4:7], s64 offen
  buffer_load_dwordx4 v[100:103], v17, s[4:7], s64 offen offset:1024
  s_lshl_b32 s68, s51, 6
  s_lshl_b32 s69, s52, 1
  s_add_u32 s68, s68, s69
  s_lshr_b32 s69, s50, 1
  s_add_u32 s68, s68, s69
  s_lshl_b32 s69, s68, 12
  s_and_b32 s70, s50, 1
  s_lshl_b32 s71, s70, 11
  s_add_u32 s69, s69, s71
  buffer_load_dwordx4 v[104:107], v17, s[20:23], s69 offen offset:0
  buffer_load_dwordx2 v[108:109], v17, s[20:23], s69 offen offset:16
  buffer_load_dwordx4 v[110:113], v17, s[20:23], s69 offen offset:1024
  buffer_load_dwordx2 v[114:115], v17, s[20:23], s69 offen offset:1040
  s_lshl_b32 s71, s68, 1
  v_mov_b32 v18, 0
  buffer_load_ushort v116, v18, s[24:27], s71 offen
  v_lshrrev_b32 v19, 2, v2
  v_add_u32 v19, s58, v19
  v_and_b32 v20, 3, v2
  v_lshlrev_b32 v20, 2, v20
  v_lshl_add_u32 v20, v3, 10, v20
  v_xor_b32 v21, v19, v3
  v_lshl_add_u32 v21, v21, 4, v20
  v_add_u32 v22, 1, v3
  v_and_b32 v22, 7, v22
  v_xor_b32 v22, v19, v22
  v_lshl_add_u32 v22, v22, 4, v20
  s_lshl_b32 s64, s52, 7
  s_sub_u32 s64, 4080, s64
  v_lshlrev_b32 v5, 4, v3
  v_sub_u32 v5, s64, v5
  v_lshl_add_u32 v5, v2, 13, v5
  s_lshl_b32 s65, s51, 18
  s_lshl_b32 s66, s50, 16
  s_add_u32 s65, s65, s66
  s_add_u32 s72, s65, 1048576
  s_add_u32 s73, s72, 4096
  v_add_u32 v23, 124160, v21
  v_add_u32 v21, 114944, v21
  v_add_u32 v22, 114944, v22
  s_waitcnt vmcnt(9)
  s_barrier
  v_mov_b32 v16, 0
  global_load_dwordx2 v[18:19], v16, s[48:49] sc1
  ds_read_b32 v24, v21 offset:640
  ds_read_b32 v25, v21 offset:768
  ds_read_b32 v26, v21 offset:896
  ds_read_b32 v27, v22 offset:1024
  ds_read_b32 v28, v22 offset:1152
  ds_read_b32 v29, v22 offset:1280
  ds_read_b32 v30, v22 offset:1408
  ds_read_b32 v31, v22 offset:1536
  ds_read_b32 v32, v22 offset:1664
  ds_read_b32 v33, v22 offset:1792
  ds_read_b32 v34, v22 offset:1920
  v_lshlrev_b32 v82, 16, v12
  v_lshlrev_b32 v83, 16, v14
  v_and_b32 v84, 0xffff0000, v12
  v_and_b32 v85, 0xffff0000, v14
  v_lshlrev_b32 v86, 16, v13
  v_lshlrev_b32 v87, 16, v15
  v_and_b32 v88, 0xffff0000, v13
  v_and_b32 v89, 0xffff0000, v15
  s_waitcnt lgkmcnt(8)
  v_lshlrev_b32 v36, 16, v24
  v_and_b32 v37, 0xffff0000, v24
  v_lshlrev_b32 v38, 16, v25
  v_and_b32 v39, 0xffff0000, v25
  v_lshlrev_b32 v40, 16, v26
  v_and_b32 v41, 0xffff0000, v26
  ds_read_b32 v58, v23 offset:0
  ds_read_b32 v59, v23 offset:128
  ds_read_b32 v60, v23 offset:256
  ds_read_b32 v61, v23 offset:384
  ds_read_b32 v62, v23 offset:512
  ds_read_b32 v63, v23 offset:640
  ds_read_b32 v64, v23 offset:768
  ds_read_b32 v65, v23 offset:896
  s_waitcnt lgkmcnt(8)
  v_lshlrev_b32 v42, 16, v27
  v_and_b32 v43, 0xffff0000, v27
  v_lshlrev_b32 v44, 16, v28
  v_and_b32 v45, 0xffff0000, v28
  v_lshlrev_b32 v46, 16, v29
  v_and_b32 v47, 0xffff0000, v29
  v_lshlrev_b32 v48, 16, v30
  v_and_b32 v49, 0xffff0000, v30
  v_lshlrev_b32 v50, 16, v31
  v_and_b32 v51, 0xffff0000, v31
  v_lshlrev_b32 v52, 16, v32
  v_and_b32 v53, 0xffff0000, v32
  v_lshlrev_b32 v54, 16, v33
  v_and_b32 v55, 0xffff0000, v33
  v_lshlrev_b32 v56, 16, v34
  v_and_b32 v57, 0xffff0000, v34
  v_pk_mul_f32 v[120:121], v[42:43], v[82:83]
  v_pk_mul_f32 v[122:123], v[44:45], v[82:83]
  v_pk_mul_f32 v[124:125], v[46:47], v[82:83]
  v_pk_mul_f32 v[126:127], v[48:49], v[82:83]
  v_pk_mul_f32 v[128:129], v[50:51], v[82:83]
  v_pk_mul_f32 v[130:131], v[52:53], v[82:83]
  v_pk_mul_f32 v[132:133], v[54:55], v[82:83]
  v_pk_mul_f32 v[134:135], v[56:57], v[82:83]
  v_pk_fma_f32 v[120:121], v[40:41], v[84:85], v[120:121]
  v_pk_fma_f32 v[122:123], v[42:43], v[84:85], v[122:123]
  v_pk_fma_f32 v[124:125], v[44:45], v[84:85], v[124:125]
  v_pk_fma_f32 v[126:127], v[46:47], v[84:85], v[126:127]
  v_pk_fma_f32 v[128:129], v[48:49], v[84:85], v[128:129]
  v_pk_fma_f32 v[130:131], v[50:51], v[84:85], v[130:131]
  v_pk_fma_f32 v[132:133], v[52:53], v[84:85], v[132:133]
  v_pk_fma_f32 v[134:135], v[54:55], v[84:85], v[134:135]
  v_pk_fma_f32 v[120:121], v[38:39], v[86:87], v[120:121]
  v_pk_fma_f32 v[122:123], v[40:41], v[86:87], v[122:123]
  v_pk_fma_f32 v[124:125], v[42:43], v[86:87], v[124:125]
  v_pk_fma_f32 v[126:127], v[44:45], v[86:87], v[126:127]
  v_pk_fma_f32 v[128:129], v[46:47], v[86:87], v[128:129]
  v_pk_fma_f32 v[130:131], v[48:49], v[86:87], v[130:131]
  v_pk_fma_f32 v[132:133], v[50:51], v[86:87], v[132:133]
  v_pk_fma_f32 v[134:135], v[52:53], v[86:87], v[134:135]
  v_pk_fma_f32 v[120:121], v[36:37], v[88:89], v[120:121]
  v_pk_fma_f32 v[122:123], v[38:39], v[88:89], v[122:123]
  v_pk_fma_f32 v[124:125], v[40:41], v[88:89], v[124:125]
  v_pk_fma_f32 v[126:127], v[42:43], v[88:89], v[126:127]
  v_pk_fma_f32 v[128:129], v[44:45], v[88:89], v[128:129]
  v_pk_fma_f32 v[130:131], v[46:47], v[88:89], v[130:131]
  v_pk_fma_f32 v[132:133], v[48:49], v[88:89], v[132:133]
  v_pk_fma_f32 v[134:135], v[50:51], v[88:89], v[134:135]
  s_waitcnt lgkmcnt(0)
  v_lshlrev_b32 v66, 16, v58
  v_and_b32 v67, 0xffff0000, v58
  v_lshlrev_b32 v68, 16, v59
  v_and_b32 v69, 0xffff0000, v59
  v_lshlrev_b32 v70, 16, v60
  v_and_b32 v71, 0xffff0000, v60
  v_lshlrev_b32 v72, 16, v61
  v_and_b32 v73, 0xffff0000, v61
  v_lshlrev_b32 v74, 16, v62
  v_and_b32 v75, 0xffff0000, v62
  v_lshlrev_b32 v76, 16, v63
  v_and_b32 v77, 0xffff0000, v63
  v_lshlrev_b32 v78, 16, v64
  v_and_b32 v79, 0xffff0000, v64
  v_lshlrev_b32 v80, 16, v65
  v_and_b32 v81, 0xffff0000, v65
  v_pk_mul_f32 v[120:121], v[120:121], v[66:67]
  v_pk_mul_f32 v[122:123], v[122:123], v[68:69]
  v_pk_mul_f32 v[124:125], v[124:125], v[70:71]
  v_pk_mul_f32 v[126:127], v[126:127], v[72:73]
  v_pk_mul_f32 v[128:129], v[128:129], v[74:75]
  v_pk_mul_f32 v[130:131], v[130:131], v[76:77]
  v_pk_mul_f32 v[132:133], v[132:133], v[78:79]
  v_pk_mul_f32 v[134:135], v[134:135], v[80:81]
  v_cvt_pk_bf16_f32 v24, v134, v126
  v_cvt_pk_bf16_f32 v25, v132, v124
  v_cvt_pk_bf16_f32 v26, v130, v122
  v_cvt_pk_bf16_f32 v27, v128, v120
  v_cvt_pk_bf16_f32 v28, v135, v127
  v_cvt_pk_bf16_f32 v29, v133, v125
  v_cvt_pk_bf16_f32 v30, v131, v123
  v_cvt_pk_bf16_f32 v31, v129, v121
  buffer_store_dwordx4 v[24:27], v5, s[44:47], s72 offen sc1
  buffer_store_dwordx4 v[28:31], v5, s[44:47], s73 offen sc1
  v_add_u32 v23, 8192, v23
  s_waitcnt vmcnt(2)
  v_readfirstlane_b32 s54, v18
  v_readfirstlane_b32 s55, v19
  s_mov_b32 s3, 0
  s_nop 0
  s_cmp_lg_u32 s54, 0
  s_cbranch_scc1 L_npd_3
L_np_2:
  global_load_dwordx2 v[18:19], v16, s[48:49] sc1
  s_add_u32 s3, s3, 1
  s_waitcnt vmcnt(0)
  v_readfirstlane_b32 s54, v18
  v_readfirstlane_b32 s55, v19
  s_cmp_ge_u32 s3, 1048576
  s_cbranch_scc1 L_npd_3
  s_cmp_eq_u32 s54, 0
  s_cbranch_scc1 L_np_2
L_npd_3:
  v_lshlrev_b32 v58, 16, v96
  v_and_b32 v59, 0xffff0000, v96
  v_lshlrev_b32 v60, 16, v97
  v_and_b32 v61, 0xffff0000, v97
  v_lshlrev_b32 v62, 16, v98
  v_and_b32 v63, 0xffff0000, v98
  v_lshlrev_b32 v64, 16, v99
  v_and_b32 v65, 0xffff0000, v99
  v_lshlrev_b32 v66, 16, v100
  v_and_b32 v67, 0xffff0000, v100
  v_lshlrev_b32 v68, 16, v101
  v_and_b32 v69, 0xffff0000, v101
  v_lshlrev_b32 v70, 16, v102
  v_and_b32 v71, 0xffff0000, v102
  v_lshlrev_b32 v72, 16, v103
  v_and_b32 v73, 0xffff0000, v103
  v_pk_add_f32 v[74:75], v[58:59], v[60:61]
  v_pk_add_f32 v[76:77], v[66:67], v[68:69]
  v_pk_add_f32 v[74:75], v[74:75], v[62:63]
  v_pk_add_f32 v[76:77], v[76:77], v[70:71]
  v_pk_add_f32 v[74:75], v[74:75], v[64:65]
  v_pk_add_f32 v[76:77], v[76:77], v[72:73]
  v_add_f32 v78, v74, v75
  v_add_f32 v79, v76, v77
  s_nop 0
  v_add_f32_dpp v78, v78, v78 row_shr:1 row_mask:0xf bank_mask:0xf bound_ctrl:1
  v_add_f32_dpp v79, v79, v79 row_shr:1 row_mask:0xf bank_mask:0xf bound_ctrl:1
  s_nop 0
  v_add_f32_dpp v78, v78, v78 row_shr:2 row_mask:0xf bank_mask:0xf bound_ctrl:1
  v_add_f32_dpp v79, v79, v79 row_shr:2 row_mask:0xf bank_mask:0xf bound_ctrl:1
  s_nop 0
  v_add_f32_dpp v78, v78, v78 row_shr:4 row_mask:0xf bank_mask:0xf bound_ctrl:1
  v_add_f32_dpp v79, v79, v79 row_shr:4 row_mask:0xf bank_mask:0xf bound_ctrl:1
  s_nop 0
  v_add_f32_dpp v78, v78, v78 row_shr:8 row_mask:0xf bank_mask:0xf bound_ctrl:1
  v_add_f32_dpp v79, v79, v79 row_shr:8 row_mask:0xf bank_mask:0xf bound_ctrl:1
  s_nop 0
  v_add_f32_dpp v78, v78, v78 row_bcast:15 row_mask:0xa bank_mask:0xf
  v_add_f32_dpp v79, v79, v79 row_bcast:15 row_mask:0xa bank_mask:0xf
  s_nop 0
  v_add_f32_dpp v78, v78, v78 row_bcast:31 row_mask:0xc bank_mask:0xf
  v_add_f32_dpp v79, v79, v79 row_bcast:31 row_mask:0xc bank_mask:0xf
  v_readlane_b32 s74, v78, 63
  v_readlane_b32 s75, v79, 63
  v_mov_b32 v80, 0x3b000000
  v_mul_f32 v78, s74, v80
  v_mul_f32 v79, s75, v80
  v_sub_f32 v58, v58, v78
  v_sub_f32 v59, v59, v78
  v_sub_f32 v60, v60, v78
  v_sub_f32 v61, v61, v78
  v_sub_f32 v62, v62, v78
  v_sub_f32 v63, v63, v78
  v_sub_f32 v64, v64, v78
  v_sub_f32 v65, v65, v78
  v_sub_f32 v66, v66, v79
  v_sub_f32 v67, v67, v79
  v_sub_f32 v68, v68, v79
  v_sub_f32 v69, v69, v79
  v_sub_f32 v70, v70, v79
  v_sub_f32 v71, v71, v79
  v_sub_f32 v72, v72, v79
  v_sub_f32 v73, v73, v79
  v_pk_mul_f32 v[74:75], v[58:59], v[58:59]
  v_pk_mul_f32 v[76:77], v[66:67], v[66:67]
  v_pk_fma_f32 v[74:75], v[60:61], v[60:61], v[74:75]
  v_pk_fma_f32 v[76:77], v[68:69], v[68:69], v[76:77]
  v_pk_fma_f32 v[74:75], v[62:63], v[62:63], v[74:75]
  v_pk_fma_f32 v[76:77], v[70:71], v[70:71], v[76:77]
  v_pk_fma_f32 v[74:75], v[64:65], v[64:65], v[74:75]
  v_pk_fma_f32 v[76:77], v[72:73], v[72:73], v[76:77]
  v_add_f32 v82, v74, v75
  v_add_f32 v83, v76, v77
  s_nop 0
  v_add_f32_dpp v82, v82, v82 row_shr:1 row_mask:0xf bank_mask:0xf bound_ctrl:1
  v_add_f32_dpp v83, v83, v83 row_shr:1 row_mask:0xf bank_mask:0xf bound_ctrl:1
  s_nop 0
  v_add_f32_dpp v82, v82, v82 row_shr:2 row_mask:0xf bank_mask:0xf bound_ctrl:1
  v_add_f32_dpp v83, v83, v83 row_shr:2 row_mask:0xf bank_mask:0xf bound_ctrl:1
  s_nop 0
  v_add_f32_dpp v82, v82, v82 row_shr:4 row_mask:0xf bank_mask:0xf bound_ctrl:1
  v_add_f32_dpp v83, v83, v83 row_shr:4 row_mask:0xf bank_mask:0xf bound_ctrl:1
  s_nop 0
  v_add_f32_dpp v82, v82, v82 row_shr:8 row_mask:0xf bank_mask:0xf bound_ctrl:1
  v_add_f32_dpp v83, v83, v83 row_shr:8 row_mask:0xf bank_mask:0xf bound_ctrl:1
  s_nop 0
  v_add_f32_dpp v82, v82, v82 row_bcast:15 row_mask:0xa bank_mask:0xf
  v_add_f32_dpp v83, v83, v83 row_bcast:15 row_mask:0xa bank_mask:0xf
  s_nop 0
  v_add_f32_dpp v82, v82, v82 row_bcast:31 row_mask:0xc bank_mask:0xf
  v_add_f32_dpp v83, v83, v83 row_bcast:31 row_mask:0xc bank_mask:0xf
  v_readlane_b32 s74, v82, 63
  v_readlane_b32 s75, v83, 63
  v_mov_b32 v81, 0x3727c5ac
  v_fma_f32 v82, s74, v80, v81
  v_fma_f32 v83, s75, v80, v81
  v_rsq_f32 v82, v82
  v_rsq_f32 v83, v83
  s_lshl_b32 s64, s2, 5
  s_lshl_b32 s65, s50, 3
  s_add_u32 s64, s64, s65
  s_add_u32 s65, s64, 131072
  s_add_u32 s66, s64, 139264
  v_mov_b32 v84, 0
  v_mov_b32 v86, v82
  v_mov_b32 v87, v83
  v_mov_b32 v88, v78
  v_mov_b32 v89, v79
  s_mov_b64 exec, 1
  buffer_store_dwordx2 v[88:89], v84, s[44:47], s65 offen sc1
  buffer_store_dwordx2 v[86:87], v84, s[44:47], s66 offen sc1
  s_mov_b64 exec, -1
  s_waitcnt vmcnt(2)
  s_barrier
  s_lshl_b32 s53, s51, 5
  s_add_u32 s53, s53, s52
  s_cmp_lg_u32 s50, 0
  s_cbranch_scc1 L_fs_4
  s_lshr_b32 s3, s53, 1
  s_lshl_b32 s3, s3, 7
  s_and_b32 s101, s53, 1
  s_lshl_b32 s101, s101, 6
  s_add_u32 s3, s3, s101
  s_add_u32 s3, s3, 0
  v_mov_b32 v250, s54
  v_mov_b32 v251, s55
  v_mov_b32 v252, 0
  s_mov_b64 exec, 1
  buffer_store_dwordx2 v[250:251], v252, s[44:47], s3 offen sc1
  s_mov_b64 exec, -1
L_fs_4:
  ds_read_b32 v36, v23 offset:0
  ds_read_b32 v37, v23 offset:128
  ds_read_b32 v38, v23 offset:256
  ds_read_b32 v39, v23 offset:384
  ds_read_b32 v40, v23 offset:512
  ds_read_b32 v41, v23 offset:640
  ds_read_b32 v42, v23 offset:768
  ds_read_b32 v43, v23 offset:896
  s_waitcnt lgkmcnt(0)
  v_perm_b32 v44, v37, v36, s96
  v_perm_b32 v45, v39, v38, s96
  v_perm_b32 v46, v41, v40, s96
  v_perm_b32 v47, v43, v42, s96
  v_perm_b32 v48, v37, v36, s97
  v_perm_b32 v49, v39, v38, s97
  v_perm_b32 v50, v41, v40, s97
  v_perm_b32 v51, v43, v42, s97
  s_lshl_b32 s64, s52, 7
  v_lshl_add_u32 v5, v3, 4, s64
  v_lshl_add_u32 v5, v2, 13, v5
  s_add_u32 s72, s72, 2097152
  s_add_u32 s73, s72, 4096
  buffer_store_dwordx4 v[44:47], v5, s[44:47], s72 offen sc1
  buffer_store_dwordx4 v[48:51], v5, s[44:47], s73 offen sc1
  v_mov_b32 v24, 0
  v_mov_b32 v25, 0
  v_mov_b32 v26, 0
  v_mov_b32 v27, 0
  v_and_b32 v28, 31, v255
  v_lshrrev_b32 v29, 5, v255
  v_mul_u32_u24 v29, 4608, v29
  v_lshl_add_u32 v28, v28, 4, v29
  v_add_u32 v28, 119040, v28
  ds_write_b128 v28, v[24:27]
  s_lshr_b32 s64, s50, 1
  s_mul_i32 s64, s64, 8256
  s_lshl_b32 s65, s70, 12
  s_add_u32 s64, s64, s65
  s_add_u32 s64, s64, 140608
  v_lshl_add_u32 v5, v255, 5, s64
  v_perm_b32 v120, v106, v104, s96
  v_perm_b32 v121, v106, v104, s97
  v_perm_b32 v122, v107, v105, s96
  v_perm_b32 v123, v107, v105, s97
  v_perm_b32 v124, v108, v106, s96
  v_perm_b32 v125, v108, v106, s97
  v_perm_b32 v126, v109, v107, s96
  v_perm_b32 v127, v109, v107, s97
  ds_write_b128 v5, v[120:123] offset:0
  ds_write_b128 v5, v[124:127] offset:16
  v_perm_b32 v128, v112, v110, s96
  v_perm_b32 v129, v112, v110, s97
  v_perm_b32 v130, v113, v111, s96
  v_perm_b32 v131, v113, v111, s97
  v_perm_b32 v132, v114, v112, s96
  v_perm_b32 v133, v114, v112, s97
  v_perm_b32 v134, v115, v113, s96
  v_perm_b32 v135, v115, v113, s97
  ds_write_b128 v5, v[128:131] offset:2048
  ds_write_b128 v5, v[132:135] offset:2064
  s_cmp_lg_u32 s70, 0
  s_cbranch_scc1 L_tz_5
  v_lshlrev_b32 v136, 16, v104
  v_and_b32 v137, 0xffff0000, v104
  v_lshlrev_b32 v138, 16, v105
  v_and_b32 v139, 0xffff0000, v105
  v_mov_b32 v140, 0
  v_mov_b32 v141, 0
  v_mov_b32 v142, 0
  v_mov_b32 v143, 0
  v_subrev_u32 v6, 64, v5
  s_mov_b64 exec, 1
  ds_write_b128 v6, v[140:143]
  ds_write_b128 v6, v[140:143] offset:16
  ds_write_b128 v6, v[140:143] offset:32
  ds_write_b128 v6, v[136:139] offset:48
  s_mov_b64 exec, -1
L_tz_5:
  s_waitcnt lgkmcnt(0)
  s_waitcnt vmcnt(0)
  s_barrier
  s_cmp_lg_u32 s50, 0
  s_cbranch_scc1 L_fs_6
  s_lshr_b32 s3, s53, 1
  s_lshl_b32 s3, s3, 7
  s_and_b32 s101, s53, 1
  s_lshl_b32 s101, s101, 6
  s_add_u32 s3, s3, s101
  s_add_u32 s3, s3, 32768
  v_mov_b32 v250, s54
  v_mov_b32 v251, s55
  v_mov_b32 v252, 0
  s_mov_b64 exec, 1
  buffer_store_dwordx2 v[250:251], v252, s[44:47], s3 offen sc1
  s_mov_b64 exec, -1
L_fs_6:
  s_lshr_b32 s64, s50, 1
  s_mul_i32 s64, s64, 8256
  s_lshl_b32 s65, s70, 9
  s_add_u32 s64, s64, s65
  s_add_u32 s64, s64, 140548
  v_and_b32 v2, 15, v255
  v_lshrrev_b32 v3, 4, v255
  v_lshl_add_u32 v4, v3, 3, v2
  v_lshl_add_u32 v4, v4, 2, s64
  ds_read2_b32 a[0:1], v4 offset0:0 offset1:1
  ds_read2_b32 a[2:3], v4 offset0:2 offset1:3
  ds_read2_b32 a[32:33], v4 offset0:32 offset1:33
  ds_read2_b32 a[34:35], v4 offset0:34 offset1:35
  ds_read2_b32 a[64:65], v4 offset0:64 offset1:65
  ds_read2_b32 a[66:67], v4 offset0:66 offset1:67
  ds_read2_b32 a[96:97], v4 offset0:96 offset1:97
  ds_read2_b32 a[98:99], v4 offset0:98 offset1:99
  v_add_u32 v4, 1024, v4
  ds_read2_b32 a[4:5], v4 offset0:0 offset1:1
  ds_read2_b32 a[6:7], v4 offset0:2 offset1:3
  ds_read2_b32 a[36:37], v4 offset0:32 offset1:33
  ds_read2_b32 a[38:39], v4 offset0:34 offset1:35
  ds_read2_b32 a[68:69], v4 offset0:64 offset1:65
  ds_read2_b32 a[70:71], v4 offset0:66 offset1:67
  ds_read2_b32 a[100:101], v4 offset0:96 offset1:97
  ds_read2_b32 a[102:103], v4 offset0:98 offset1:99
  v_add_u32 v4, 1024, v4
  ds_read2_b32 a[8:9], v4 offset0:0 offset1:1
  ds_read2_b32 a[10:11], v4 offset0:2 offset1:3
  ds_read2_b32 a[40:41], v4 offset0:32 offset1:33
  ds_read2_b32 a[42:43], v4 offset0:34 offset1:35
  ds_read2_b32 a[72:73], v4 offset0:64 offset1:65
  ds_read2_b32 a[74:75], v4 offset0:66 offset1:67
  ds_read2_b32 a[104:105], v4 offset0:96 offset1:97
  ds_read2_b32 a[106:107], v4 offset0:98 offset1:99
  v_add_u32 v4, 1024, v4
  ds_read2_b32 a[12:13], v4 offset0:0 offset1:1
  ds_read2_b32 a[14:15], v4 offset0:2 offset1:3
  ds_read2_b32 a[44:45], v4 offset0:32 offset1:33
  ds_read2_b32 a[46:47], v4 offset0:34 offset1:35
  ds_read2_b32 a[76:77], v4 offset0:64 offset1:65
  ds_read2_b32 a[78:79], v4 offset0:66 offset1:67
  ds_read2_b32 a[108:109], v4 offset0:96 offset1:97
  ds_read2_b32 a[110:111], v4 offset0:98 offset1:99
  v_add_u32 v4, 1024, v4
  ds_read2_b32 a[16:17], v4 offset0:0 offset1:1
  ds_read2_b32 a[18:19], v4 offset0:2 offset1:3
  ds_read2_b32 a[48:49], v4 offset0:32 offset1:33
  ds_read2_b32 a[50:51], v4 offset0:34 offset1:35
  ds_read2_b32 a[80:81], v4 offset0:64 offset1:65
  ds_read2_b32 a[82:83], v4 offset0:66 offset1:67
  ds_read2_b32 a[112:113], v4 offset0:96 offset1:97
  ds_read2_b32 a[114:115], v4 offset0:98 offset1:99
  v_add_u32 v4, 1024, v4
  ds_read2_b32 a[20:21], v4 offset0:0 offset1:1
  ds_read2_b32 a[22:23], v4 offset0:2 offset1:3
  ds_read2_b32 a[52:53], v4 offset0:32 offset1:33
  ds_read2_b32 a[54:55], v4 offset0:34 offset1:35
  ds_read2_b32 a[84:85], v4 offset0:64 offset1:65
  ds_read2_b32 a[86:87], v4 offset0:66 offset1:67
  ds_read2_b32 a[116:117], v4 offset0:96 offset1:97
  ds_read2_b32 a[118:119], v4 offset0:98 offset1:99
  v_add_u32 v4, 1024, v4
  ds_read2_b32 a[24:25], v4 offset0:0 offset1:1
  ds_read2_b32 a[26:27], v4 offset0:2 offset1:3
  ds_read2_b32 a[56:57], v4 offset0:32 offset1:33
  ds_read2_b32 a[58:59], v4 offset0:34 offset1:35
  ds_read2_b32 a[88:89], v4 offset0:64 offset1:65
  ds_read2_b32 a[90:91], v4 offset0:66 offset1:67
  ds_read2_b32 a[120:121], v4 offset0:96 offset1:97
  ds_read2_b32 a[122:123], v4 offset0:98 offset1:99
  v_add_u32 v4, 1024, v4
  ds_read2_b32 a[28:29], v4 offset0:0 offset1:1
  ds_read2_b32 a[30:31], v4 offset0:2 offset1:3
  ds_read2_b32 a[60:61], v4 offset0:32 offset1:33
  ds_read2_b32 a[62:63], v4 offset0:34 offset1:35
  ds_read2_b32 a[92:93], v4 offset0:64 offset1:65
  ds_read2_b32 a[94:95], v4 offset0:66 offset1:67
  ds_read2_b32 a[124:125], v4 offset0:96 offset1:97
  ds_read2_b32 a[126:127], v4 offset0:98 offset1:99
  v_sub_u32 v5, 15, v2
  v_lshlrev_b32 v6, 3, v3
  v_sub_u32 v5, v5, v6
  s_cmp_eq_u32 s70, 0
  s_cselect_b32 s64, -1, 0
  v_and_b32 v7, s64, v116
  v_lshlrev_b32 v8, 16, v7
  v_cmp_eq_u32 vcc, 0, v5
  s_nop 1
  v_cndmask_b32 v9, 0, v7, vcc
  v_cmp_eq_u32 vcc, 4, v5
  s_nop 1
  v_cndmask_b32 v96, v9, v8, vcc
  v_cmp_eq_u32 vcc, 1, v5
  s_nop 1
  v_cndmask_b32 v9, 0, v7, vcc
  v_cmp_eq_u32 vcc, 5, v5
  s_nop 1
  v_cndmask_b32 v97, v9, v8, vcc
  v_cmp_eq_u32 vcc, 2, v5
  s_nop 1
  v_cndmask_b32 v9, 0, v7, vcc
  v_cmp_eq_u32 vcc, 6, v5
  s_nop 1
  v_cndmask_b32 v98, v9, v8, vcc
  v_cmp_eq_u32 vcc, 3, v5
  s_nop 1
  v_cndmask_b32 v9, 0, v7, vcc
  v_cmp_eq_u32 vcc, 7, v5
  s_nop 1
  v_cndmask_b32 v99, v9, v8, vcc
  s_cmp_ge_u32 s2, 224
  s_cselect_b32 s64, 32, 0
  s_sub_u32 s98, s2, s64
  s_lshr_b32 s64, s98, 2
  s_and_b32 s65, s98, 3
  s_lshl_b32 s66, s64, 15
  s_lshl_b32 s67, s65, 8
  s_add_u32 s66, s66, s67
  s_lshl_b32 s67, s50, 6
  s_add_u32 s56, s66, s67
  s_lshl_b32 s66, s64, 15
  s_lshl_b32 s67, s65, 13
  s_add_u32 s66, s66, s67
  s_lshl_b32 s67, s50, 11
  s_add_u32 s66, s66, s67
  s_add_u32 s57, s66, 7340032
  s_cmp_ge_u32 s64, 28
  s_cselect_b32 s92, s32, s28
  s_cselect_b32 s93, s33, s29
  s_cselect_b32 s66, 28, 0
  s_cselect_b32 s67, 7168, 0
  s_mov_b32 s94, 1835008
  s_mov_b32 s95, 0x20000
  s_sub_u32 s64, s64, s66
  s_lshl_b32 s66, s64, 8
  s_add_u32 s66, s66, s67
  s_mul_i32 s67, s65, 14336
  s_add_u32 s66, s66, s67
  s_add_u32 s59, s66, 147456
  s_lshl_b32 s64, s64, 7
  s_lshl_b32 s65, s65, 2
  s_add_u32 s65, s65, s50
  s_mul_i32 s65, s65, 114688
  s_add_u32 s58, s64, s65
  v_lshrrev_b32 v28, 2, v255
  v_and_b32 v29, 3, v255
  v_lshlrev_b32 v28, 10, v28
  v_lshl_add_u32 v40, v29, 4, v28
  v_lshrrev_b32 v28, 3, v255
  v_mul_u32_u24 v28, 3584, v28
  v_and_b32 v29, 7, v255
  v_lshl_add_u32 v41, v29, 4, v28
  v_lshrrev_b32 v28, 4, v255
  v_bfe_u32 v29, v255, 2, 2
  v_lshl_add_u32 v28, v28, 3, v29
  v_and_b32 v29, 3, v255
  v_lshlrev_b32 v28, 6, v28
  v_lshl_add_u32 v28, v29, 3, v28
  s_lshl_b32 s64, s50, 12
  s_add_u32 s65, s64, 140544
  v_add_u32 v42, s65, v28
  v_lshrrev_b32 v28, 2, v255
  v_lshlrev_b32 v28, 7, v28
  v_lshl_add_u32 v28, v29, 3, v28
  s_add_u32 s65, s64, 124160
  v_add_u32 v43, s65, v28
  s_cmp_lg_u32 s50, 0
  s_cbranch_scc1 L_s1w_7
  s_lshl_b32 s64, s51, 5
  v_add_u32 v3, s64, v255
  v_lshrrev_b32 v2, 1, v3
  v_lshlrev_b32 v2, 7, v2
  v_and_b32 v3, 1, v3
  v_lshl_add_u32 v2, v3, 6, v2
  s_mov_b32 s3, 0
  s_bfm_b64 exec, 32, 0
L_poll_8:
  buffer_load_dwordx2 v[236:237], v2, s[44:47], 0 offen sc1
  s_add_u32 s3, s3, 1
  s_waitcnt vmcnt(0)
  v_cmp_ne_u64 vcc, s[54:55], v[236:237]
  s_cmp_ge_u32 s3, 1048576
  s_cbranch_scc1 L_polld_9
  s_nop 0
  s_and_b64 exec, exec, vcc
  s_cbranch_execz L_polld_9
  s_branch L_poll_8
L_polld_9:
  s_mov_b64 exec, -1
L_s1w_7:
  s_waitcnt lgkmcnt(0)
  s_barrier
  s_lshl_b32 s64, s68, 12
  s_lshl_b32 s65, s70, 11
  s_add_u32 s64, s64, s65
  s_add_u32 s72, s64, 1048576
  s_lshr_b32 s66, s50, 1
  s_mul_i32 s66, s66, 4608
  s_add_u32 s67, s66, s65
  s_add_u32 s67, s67, 114944
  v_lshlrev_b32 v2, 4, v255
  s_mov_b32 m0, s67
  s_add_u32 s73, s72, 1024
  buffer_load_dwordx4 v2, s[44:47], s72 offen sc1 lds
  s_add_u32 m0, s67, 1024
  s_nop 0
  buffer_load_dwordx4 v2, s[44:47], s73 offen sc1 lds
  s_lshl_b32 s64, s50, 6
  v_add_u32 v4, s64, v255
  v_lshrrev_b32 v3, 1, v4
  v_lshlrev_b32 v3, 7, v3
  v_and_b32 v4, 1, v4
  v_lshl_add_u32 v3, v4, 6, v3
  v_add_u32 v3, 32768, v3
  buffer_load_dwordx2 v[236:237], v3, s[44:47], 0 offen sc1
  s_lshl_b32 s99, s50, 12
  s_add_u32 m0, s99, 140544
  s_add_u32 s98, s56, 16384
  buffer_load_dwordx4 v40, s[36:39], s56 offen lds
  s_add_u32 m0, s99, 141568
  s_nop 0
  buffer_load_dwordx4 v40, s[36:39], s98 offen lds
  s_add_u32 m0, s99, 124160
  s_add_u32 s98, s58, 0
  buffer_load_dwordx4 v41, s[92:95], s98 offen lds
  s_add_u32 m0, s99, 125184
  s_add_u32 s98, s58, 28672
  buffer_load_dwordx4 v41, s[92:95], s98 offen lds
  s_add_u32 m0, s99, 126208
  s_add_u32 s98, s58, 57344
  buffer_load_dwordx4 v41, s[92:95], s98 offen lds
  s_add_u32 m0, s99, 127232
  s_add_u32 s98, s58, 86016
  buffer_load_dwordx4 v41, s[92:95], s98 offen lds
  v_and_b32 v8, 15, v255
  v_lshrrev_b32 v9, 4, v255
  v_lshlrev_b32 v4, 4, v8
  v_lshl_add_u32 v4, v9, 2, v4
  s_lshl_b32 s64, s70, 10
  v_add_u32 v4, s64, v4
  v_lshlrev_b32 v5, 1, v4
  v_lshlrev_b32 v6, 2, v4
  s_lshl_b32 s72, s68, 12
  s_add_u32 s73, s72, 3145728
  s_add_u32 s74, s72, 5242880
  s_mov_b32 s75, 131072
  s_mov_b32 s76, 139264
  v_lshlrev_b32 v7, 5, v8
  v_lshlrev_b32 v8, 4, v9
  v_sub_u32 v7, v8, v7
  s_lshl_b32 s64, s70, 8
  s_add_u32 s64, s64, s66
  s_add_u32 s64, s64, 115424
  v_add_u32 v7, s64, v7
  s_mov_b32 s3, 0
  s_waitcnt vmcnt(6)
  v_cmp_ne_u64 vcc, s[54:55], v[236:237]
  s_nop 2
  s_and_b64 exec, exec, vcc
  s_cbranch_execz L_polld_12
L_poll_11:
  buffer_load_dwordx2 v[236:237], v3, s[44:47], 0 offen sc1
  s_add_u32 s3, s3, 1
  s_waitcnt vmcnt(0)
  v_cmp_ne_u64 vcc, s[54:55], v[236:237]
  s_cmp_ge_u32 s3, 1048576
  s_cbranch_scc1 L_polld_12
  s_nop 0
  s_and_b64 exec, exec, vcc
  s_cbranch_execz L_polld_12
  s_branch L_poll_11
L_polld_12:
  s_mov_b64 exec, -1
  s_barrier
  ds_read_b128 a[128:131], v7 offset:3584
  ds_read_b128 a[132:135], v7 offset:3072
  ds_read_b128 a[136:139], v7 offset:2560
  ds_read_b128 a[140:143], v7 offset:2048
  ds_read_b128 a[144:147], v7 offset:1536
  ds_read_b128 a[148:151], v7 offset:1024
  ds_read_b128 a[152:155], v7 offset:512
  ds_read_b128 a[156:159], v7 offset:0
  s_waitcnt lgkmcnt(7)
  v_mfma_f32_16x16x32_bf16 v[64:67], a[0:3], a[128:131], 0
  s_and_b32 s64, s2, 7
  v_mfma_f32_16x16x32_bf16 v[68:71], a[4:7], a[128:131], 0
  s_lshr_b32 s65, s2, 3
  s_lshr_b32 s66, s64, 1
  v_mfma_f32_16x16x32_bf16 v[72:75], a[8:11], a[128:131], 0
  s_lshl_b32 s66, s66, 2
  ds_read_b128 a[160:163], v7 offset:3648
  v_mfma_f32_16x16x32_bf16 v[76:79], a[12:15], a[128:131], 0
  s_and_b32 s67, s65, 3
  s_add_u32 s77, s66, s67
  v_mfma_f32_16x16x32_bf16 v[80:83], a[16:19], a[128:131], 0
  s_and_b32 s66, s64, 1
  s_lshl_b32 s66, s66, 3
  v_mfma_f32_16x16x32_bf16 v[84:87], a[20:23], a[128:131], 0
  s_lshr_b32 s67, s65, 2
  s_add_u32 s78, s66, s67
  v_mfma_f32_16x16x32_bf16 v[88:91], a[24:27], a[128:131], 0
  s_lshr_b32 s79, s50, 1
  s_and_b32 s80, s50, 1
  v_mfma_f32_16x16x32_bf16 v[92:95], a[28:31], a[128:131], 0
  s_cmp_eq_u32 s79, 0
  s_cselect_b32 s60, s28, s32
  v_mfma_f32_16x16x32_bf16 v[64:67], v[96:99], a[128:131], v[64:67]
  s_cselect_b32 s61, s29, s33
  ds_read_b128 a[164:167], v7 offset:3136
  s_waitcnt lgkmcnt(8)
  v_mfma_f32_16x16x32_bf16 v[68:71], a[0:3], a[132:135], v[68:71]
  s_mov_b32 s62, 1835008
  s_mov_b32 s63, 0x20000
  v_mfma_f32_16x16x32_bf16 v[72:75], a[4:7], a[132:135], v[72:75]
  s_mul_i32 s64, s80, 448
  s_mul_i32 s65, s78, 224
  v_mfma_f32_16x16x32_bf16 v[76:79], a[8:11], a[132:135], v[76:79]
  s_movk_i32 s66, 4682
  s_movk_i32 s67, 3584
  v_mfma_f32_16x16x32_bf16 v[80:83], a[12:15], a[132:135], v[80:83]
  s_mul_i32 s84, s79, 14352
  s_lshl_b32 s3, s64, 4
  v_mfma_f32_16x16x32_bf16 v[84:87], a[16:19], a[132:135], v[84:87]
  s_add_u32 s84, s84, s3
  v_add_u32 v28, s64, v255
  v_mfma_f32_16x16x32_bf16 v[88:91], a[20:23], a[132:135], v[88:91]
  v_add_u32 v28, 0, v28
  ds_read_b128 a[168:171], v7 offset:2624
  v_mfma_f32_16x16x32_bf16 v[92:95], a[24:27], a[132:135], v[92:95]
  v_mul_u32_u24 v29, s66, v28
  v_lshrrev_b32 v29, 16, v29
  v_mfma_f32_16x16x32_bf16 v[68:71], v[96:99], a[132:135], v[68:71]
  v_mul_u32_u24 v30, 14, v29
  v_sub_u32 v30, v28, v30
  s_waitcnt lgkmcnt(8)
  v_mfma_f32_16x16x32_bf16 v[72:75], a[0:3], a[136:139], v[72:75]
  v_mul_u32_u24 v29, s67, v29
  v_lshl_add_u32 v29, v30, 4, v29
  v_mfma_f32_16x16x32_bf16 v[76:79], a[4:7], a[136:139], v[76:79]
  v_add_u32 v12, s65, v29
  v_add_u32 v28, s64, v255
  v_mfma_f32_16x16x32_bf16 v[80:83], a[8:11], a[136:139], v[80:83]
  v_add_u32 v28, 64, v28
  v_mul_u32_u24 v29, s66, v28
  v_mfma_f32_16x16x32_bf16 v[84:87], a[12:15], a[136:139], v[84:87]
  v_lshrrev_b32 v29, 16, v29
  ds_read_b128 a[172:175], v7 offset:2112
  v_mfma_f32_16x16x32_bf16 v[88:91], a[16:19], a[136:139], v[88:91]
  v_mul_u32_u24 v30, 14, v29
  v_sub_u32 v30, v28, v30
  v_mfma_f32_16x16x32_bf16 v[92:95], a[20:23], a[136:139], v[92:95]
  v_mul_u32_u24 v29, s67, v29
  v_lshl_add_u32 v29, v30, 4, v29
  v_mfma_f32_16x16x32_bf16 v[72:75], v[96:99], a[136:139], v[72:75]
  v_add_u32 v13, s65, v29
  v_add_u32 v28, s64, v255
  s_waitcnt lgkmcnt(8)
  v_mfma_f32_16x16x32_bf16 v[76:79], a[0:3], a[140:143], v[76:79]
  v_add_u32 v28, 128, v28
  v_mul_u32_u24 v29, s66, v28
  v_mfma_f32_16x16x32_bf16 v[80:83], a[4:7], a[140:143], v[80:83]
  v_lshrrev_b32 v29, 16, v29
  v_mul_u32_u24 v30, 14, v29
  v_mfma_f32_16x16x32_bf16 v[84:87], a[8:11], a[140:143], v[84:87]
  v_sub_u32 v30, v28, v30
  ds_read_b128 a[176:179], v7 offset:1600
  v_mfma_f32_16x16x32_bf16 v[88:91], a[12:15], a[140:143], v[88:91]
  v_mul_u32_u24 v29, s67, v29
  v_lshl_add_u32 v29, v30, 4, v29
  v_mfma_f32_16x16x32_bf16 v[92:95], a[16:19], a[140:143], v[92:95]
  v_add_u32 v14, s65, v29
  v_add_u32 v28, s64, v255
  v_mfma_f32_16x16x32_bf16 v[76:79], v[96:99], a[140:143], v[76:79]
  v_add_u32 v28, 192, v28
  v_mul_u32_u24 v29, s66, v28
  s_waitcnt lgkmcnt(8)
  v_mfma_f32_16x16x32_bf16 v[80:83], a[0:3], a[144:147], v[80:83]
  v_lshrrev_b32 v29, 16, v29
  v_mul_u32_u24 v30, 14, v29
  v_mfma_f32_16x16x32_bf16 v[84:87], a[4:7], a[144:147], v[84:87]
  v_sub_u32 v30, v28, v30
  v_mul_u32_u24 v29, s67, v29
  v_mfma_f32_16x16x32_bf16 v[88:91], a[8:11], a[144:147], v[88:91]
  v_lshl_add_u32 v29, v30, 4, v29
  ds_read_b128 a[180:183], v7 offset:1088
  v_mfma_f32_16x16x32_bf16 v[92:95], a[12:15], a[144:147], v[92:95]
  v_add_u32 v15, s65, v29
  v_add_u32 v28, s64, v255
  v_mfma_f32_16x16x32_bf16 v[80:83], v[96:99], a[144:147], v[80:83]
  v_add_u32 v28, 256, v28
  v_mul_u32_u24 v29, s66, v28
  s_waitcnt lgkmcnt(8)
  v_mfma_f32_16x16x32_bf16 v[84:87], a[0:3], a[148:151], v[84:87]
  v_lshrrev_b32 v29, 16, v29
  v_mul_u32_u24 v30, 14, v29
  v_mfma_f32_16x16x32_bf16 v[88:91], a[4:7], a[148:151], v[88:91]
  v_sub_u32 v30, v28, v30
  v_mul_u32_u24 v29, s67, v29
  v_mfma_f32_16x16x32_bf16 v[92:95], a[8:11], a[148:151], v[92:95]
  v_lshl_add_u32 v29, v30, 4, v29
  v_add_u32 v16, s65, v29
  v_mfma_f32_16x16x32_bf16 v[84:87], v[96:99], a[148:151], v[84:87]
  v_add_u32 v28, s64, v255
  ds_read_b128 a[184:187], v7 offset:576
  s_waitcnt lgkmcnt(8)
  v_mfma_f32_16x16x32_bf16 v[88:91], a[0:3], a[152:155], v[88:91]
  v_add_u32 v28, 320, v28
  v_mul_u32_u24 v29, s66, v28
  v_mfma_f32_16x16x32_bf16 v[92:95], a[4:7], a[152:155], v[92:95]
  v_lshrrev_b32 v29, 16, v29
  v_mul_u32_u24 v30, 14, v29
  v_mfma_f32_16x16x32_bf16 v[88:91], v[96:99], a[152:155], v[88:91]
  v_sub_u32 v30, v28, v30
  v_mul_u32_u24 v29, s67, v29
  s_waitcnt lgkmcnt(7)
  v_mfma_f32_16x16x32_bf16 v[92:95], a[0:3], a[156:159], v[92:95]
  v_lshl_add_u32 v29, v30, 4, v29
  v_add_u32 v17, s65, v29
  v_mfma_f32_16x16x32_bf16 v[92:95], v[96:99], a[156:159], v[92:95]
  v_add_u32 v28, s64, v255
  v_add_u32 v28, 384, v28
  v_mul_u32_u24 v29, s66, v28
  ds_read_b128 a[188:191], v7 offset:64
  v_lshrrev_b32 v29, 16, v29
  v_mul_u32_u24 v30, 14, v29
  v_sub_u32 v30, v28, v30
  v_mul_u32_u24 v29, s67, v29
  v_lshl_add_u32 v29, v30, 4, v29
  v_add_u32 v18, s65, v29
  s_waitcnt lgkmcnt(7)
  v_mfma_f32_16x16x32_bf16 v[64:67], a[32:35], a[160:163], v[64:67]
  buffer_load_dwordx2 v[100:101], v5, s[44:47], s73 offen offset:0 sc1
  v_mfma_f32_16x16x32_bf16 v[68:71], a[36:39], a[160:163], v[68:71]
  ds_read_b128 a[128:131], v7 offset:3712
  v_mfma_f32_16x16x32_bf16 v[72:75], a[40:43], a[160:163], v[72:75]
  v_mfma_f32_16x16x32_bf16 v[76:79], a[44:47], a[160:163], v[76:79]
  buffer_load_dwordx4 v[102:105], v6, s[44:47], s75 offen offset:0 sc1
  v_mfma_f32_16x16x32_bf16 v[80:83], a[48:51], a[160:163], v[80:83]
  v_mfma_f32_16x16x32_bf16 v[84:87], a[52:55], a[160:163], v[84:87]
  ds_read_b128 a[132:135], v7 offset:3200
  v_mfma_f32_16x16x32_bf16 v[88:91], a[56:59], a[160:163], v[88:91]
  v_mfma_f32_16x16x32_bf16 v[92:95], a[60:63], a[160:163], v[92:95]
  buffer_load_dwordx4 v[106:109], v6, s[44:47], s76 offen offset:0 sc1
  s_waitcnt lgkmcnt(8)
  v_mfma_f32_16x16x32_bf16 v[68:71], a[32:35], a[164:167], v[68:71]
  v_mfma_f32_16x16x32_bf16 v[72:75], a[36:39], a[164:167], v[72:75]
  buffer_load_dwordx2 v[110:111], v5, s[44:47], s73 offen offset:512 sc1
  v_mfma_f32_16x16x32_bf16 v[76:79], a[40:43], a[164:167], v[76:79]
  ds_read_b128 a[136:139], v7 offset:2688
  v_mfma_f32_16x16x32_bf16 v[80:83], a[44:47], a[164:167], v[80:83]
  v_mfma_f32_16x16x32_bf16 v[84:87], a[48:51], a[164:167], v[84:87]
  buffer_load_dwordx4 v[112:115], v6, s[44:47], s75 offen offset:1024 sc1
  v_mfma_f32_16x16x32_bf16 v[88:91], a[52:55], a[164:167], v[88:91]
  v_mfma_f32_16x16x32_bf16 v[92:95], a[56:59], a[164:167], v[92:95]
  ds_read_b128 a[140:143], v7 offset:2176
  s_waitcnt lgkmcnt(9)
  v_mfma_f32_16x16x32_bf16 v[72:75], a[32:35], a[168:171], v[72:75]
  v_mfma_f32_16x16x32_bf16 v[76:79], a[36:39], a[168:171], v[76:79]
  buffer_load_dwordx4 v[116:119], v6, s[44:47], s76 offen offset:1024 sc1
  v_mfma_f32_16x16x32_bf16 v[80:83], a[40:43], a[168:171], v[80:83]
  v_mfma_f32_16x16x32_bf16 v[84:87], a[44:47], a[168:171], v[84:87]
  buffer_load_dwordx2 v[120:121], v5, s[44:47], s73 offen offset:1024 sc1
  v_mfma_f32_16x16x32_bf16 v[88:91], a[48:51], a[168:171], v[88:91]
  ds_read_b128 a[144:147], v7 offset:1664
  v_mfma_f32_16x16x32_bf16 v[92:95], a[52:55], a[168:171], v[92:95]
  s_waitcnt lgkmcnt(9)
  v_mfma_f32_16x16x32_bf16 v[76:79], a[32:35], a[172:175], v[76:79]
  buffer_load_dwordx4 v[122:125], v6, s[44:47], s75 offen offset:2048 sc1
  v_mfma_f32_16x16x32_bf16 v[80:83], a[36:39], a[172:175], v[80:83]
  v_mfma_f32_16x16x32_bf16 v[84:87], a[40:43], a[172:175], v[84:87]
  ds_read_b128 a[148:151], v7 offset:1152
  v_mfma_f32_16x16x32_bf16 v[88:91], a[44:47], a[172:175], v[88:91]
  v_mfma_f32_16x16x32_bf16 v[92:95], a[48:51], a[172:175], v[92:95]
  buffer_load_dwordx4 v[126:129], v6, s[44:47], s76 offen offset:2048 sc1
  s_waitcnt lgkmcnt(9)
  v_mfma_f32_16x16x32_bf16 v[80:83], a[32:35], a[176:179], v[80:83]
  v_mfma_f32_16x16x32_bf16 v[84:87], a[36:39], a[176:179], v[84:87]
  buffer_load_dwordx2 v[130:131], v5, s[44:47], s73 offen offset:1536 sc1
  v_mfma_f32_16x16x32_bf16 v[88:91], a[40:43], a[176:179], v[88:91]
  ds_read_b128 a[152:155], v7 offset:640
  v_mfma_f32_16x16x32_bf16 v[92:95], a[44:47], a[176:179], v[92:95]
  s_waitcnt lgkmcnt(9)
  v_mfma_f32_16x16x32_bf16 v[84:87], a[32:35], a[180:183], v[84:87]
  buffer_load_dwordx4 v[132:135], v6, s[44:47], s75 offen offset:3072 sc1
  v_mfma_f32_16x16x32_bf16 v[88:91], a[36:39], a[180:183], v[88:91]
  v_mfma_f32_16x16x32_bf16 v[92:95], a[40:43], a[180:183], v[92:95]
  ds_read_b128 a[156:159], v7 offset:128
  s_waitcnt lgkmcnt(9)
  v_mfma_f32_16x16x32_bf16 v[88:91], a[32:35], a[184:187], v[88:91]
  v_mfma_f32_16x16x32_bf16 v[92:95], a[36:39], a[184:187], v[92:95]
  buffer_load_dwordx4 v[136:139], v6, s[44:47], s76 offen offset:3072 sc1
  s_waitcnt lgkmcnt(8)
  v_mfma_f32_16x16x32_bf16 v[92:95], a[32:35], a[188:191], v[92:95]
  s_waitcnt lgkmcnt(7)
  v_mfma_f32_16x16x32_bf16 v[64:67], a[64:67], a[128:131], v[64:67]
  s_mov_b32 s82, 0
  v_mfma_f32_16x16x32_bf16 v[68:71], a[68:71], a[128:131], v[68:71]
  v_mfma_f32_16x16x32_bf16 v[72:75], a[72:75], a[128:131], v[72:75]
  ds_read_b128 a[160:163], v7 offset:3776
  v_mfma_f32_16x16x32_bf16 v[76:79], a[76:79], a[128:131], v[76:79]
  v_mfma_f32_16x16x32_bf16 v[80:83], a[80:83], a[128:131], v[80:83]
  s_add_u32 m0, s84, 0
  v_mfma_f32_16x16x32_bf16 v[84:87], a[84:87], a[128:131], v[84:87]
  v_mfma_f32_16x16x32_bf16 v[88:91], a[88:91], a[128:131], v[88:91]
  ds_read_b128 a[164:167], v7 offset:3264
  v_mfma_f32_16x16x32_bf16 v[92:95], a[92:95], a[128:131], v[92:95]
  s_waitcnt lgkmcnt(8)
  v_mfma_f32_16x16x32_bf16 v[68:71], a[64:67], a[132:135], v[68:71]
  buffer_load_dwordx4 v12, s[60:63], s82 offen lds
  v_mfma_f32_16x16x32_bf16 v[72:75], a[68:71], a[132:135], v[72:75]
  v_mfma_f32_16x16x32_bf16 v[76:79], a[72:75], a[132:135], v[76:79]
  ds_read_b128 a[168:171], v7 offset:2752
  v_mfma_f32_16x16x32_bf16 v[80:83], a[76:79], a[132:135], v[80:83]
  v_mfma_f32_16x16x32_bf16 v[84:87], a[80:83], a[132:135], v[84:87]
  s_add_u32 m0, s84, 1024
  v_mfma_f32_16x16x32_bf16 v[88:91], a[84:87], a[132:135], v[88:91]
  v_mfma_f32_16x16x32_bf16 v[92:95], a[88:91], a[132:135], v[92:95]
  ds_read_b128 a[172:175], v7 offset:2240
  s_waitcnt lgkmcnt(9)
  v_mfma_f32_16x16x32_bf16 v[72:75], a[64:67], a[136:139], v[72:75]
  v_mfma_f32_16x16x32_bf16 v[76:79], a[68:71], a[136:139], v[76:79]
  buffer_load_dwordx4 v13, s[60:63], s82 offen lds
  v_mfma_f32_16x16x32_bf16 v[80:83], a[72:75], a[136:139], v[80:83]
  v_mfma_f32_16x16x32_bf16 v[84:87], a[76:79], a[136:139], v[84:87]
  v_mfma_f32_16x16x32_bf16 v[88:91], a[80:83], a[136:139], v[88:91]
  ds_read_b128 a[176:179], v7 offset:1728
  v_mfma_f32_16x16x32_bf16 v[92:95], a[84:87], a[136:139], v[92:95]
  s_waitcnt lgkmcnt(9)
  v_mfma_f32_16x16x32_bf16 v[76:79], a[64:67], a[140:143], v[76:79]
  s_add_u32 m0, s84, 2048
  v_mfma_f32_16x16x32_bf16 v[80:83], a[68:71], a[140:143], v[80:83]
  v_mfma_f32_16x16x32_bf16 v[84:87], a[72:75], a[140:143], v[84:87]
  ds_read_b128 a[180:183], v7 offset:1216
  v_mfma_f32_16x16x32_bf16 v[88:91], a[76:79], a[140:143], v[88:91]
  v_mfma_f32_16x16x32_bf16 v[92:95], a[80:83], a[140:143], v[92:95]
  buffer_load_dwordx4 v14, s[60:63], s82 offen lds
  s_waitcnt lgkmcnt(9)
  v_mfma_f32_16x16x32_bf16 v[80:83], a[64:67], a[144:147], v[80:83]
  v_mfma_f32_16x16x32_bf16 v[84:87], a[68:71], a[144:147], v[84:87]
  ds_read_b128 a[184:187], v7 offset:704
  v_mfma_f32_16x16x32_bf16 v[88:91], a[72:75], a[144:147], v[88:91]
  v_mfma_f32_16x16x32_bf16 v[92:95], a[76:79], a[144:147], v[92:95]
  s_add_u32 m0, s84, 3072
  s_waitcnt lgkmcnt(9)
  v_mfma_f32_16x16x32_bf16 v[84:87], a[64:67], a[148:151], v[84:87]
  v_mfma_f32_16x16x32_bf16 v[88:91], a[68:71], a[148:151], v[88:91]
  ds_read_b128 a[188:191], v7 offset:192
  v_mfma_f32_16x16x32_bf16 v[92:95], a[72:75], a[148:151], v[92:95]
  s_waitcnt lgkmcnt(9)
  v_mfma_f32_16x16x32_bf16 v[88:91], a[64:67], a[152:155], v[88:91]
  buffer_load_dwordx4 v15, s[60:63], s82 offen lds
  v_mfma_f32_16x16x32_bf16 v[92:95], a[68:71], a[152:155], v[92:95]
  s_waitcnt lgkmcnt(8)
  v_mfma_f32_16x16x32_bf16 v[92:95], a[64:67], a[156:159], v[92:95]
  s_waitcnt lgkmcnt(7)
  v_mfma_f32_16x16x32_bf16 v[64:67], a[96:99], a[160:163], v[64:67]
  v_mfma_f32_16x16x32_bf16 v[68:71], a[100:103], a[160:163], v[68:71]
  s_waitcnt vmcnt(16)
  ds_read_b64_tr_b16 v[188:189], v42 offset:0
  v_mfma_f32_16x16x32_bf16 v[72:75], a[104:107], a[160:163], v[72:75]
  s_add_u32 m0, s84, 4096
  ds_read_b64_tr_b16 v[190:191], v42 offset:256
  v_mfma_f32_16x16x32_bf16 v[76:79], a[108:111], a[160:163], v[76:79]
  ds_read_b64_tr_b16 v[192:193], v42 offset:32
  ds_read_b64_tr_b16 v[194:195], v42 offset:288
  v_mfma_f32_16x16x32_bf16 v[80:83], a[112:115], a[160:163], v[80:83]
  ds_read_b64_tr_b16 v[196:197], v43 offset:0
  buffer_load_dwordx4 v16, s[60:63], s82 offen lds
  v_mfma_f32_16x16x32_bf16 v[84:87], a[116:119], a[160:163], v[84:87]
  ds_read_b64_tr_b16 v[198:199], v43 offset:2048
  ds_read_b64_tr_b16 v[200:201], v43 offset:32
  v_mfma_f32_16x16x32_bf16 v[88:91], a[120:123], a[160:163], v[88:91]
  ds_read_b64_tr_b16 v[202:203], v43 offset:2080
  s_add_u32 m0, s84, 5120
  v_mfma_f32_16x16x32_bf16 v[92:95], a[124:127], a[160:163], v[92:95]
  ds_read_b64_tr_b16 v[204:205], v43 offset:64
  ds_read_b64_tr_b16 v[206:207], v43 offset:2112
  s_waitcnt lgkmcnt(15)
  v_mfma_f32_16x16x32_bf16 v[68:71], a[96:99], a[164:167], v[68:71]
  ds_read_b64_tr_b16 v[208:209], v43 offset:96
  v_mfma_f32_16x16x32_bf16 v[72:75], a[100:103], a[164:167], v[72:75]
  ds_read_b64_tr_b16 v[210:211], v43 offset:2144
  buffer_load_dwordx4 v17, s[60:63], s82 offen lds
  v_mfma_f32_16x16x32_bf16 v[76:79], a[104:107], a[164:167], v[76:79]
  v_mov_b32 v228, 0x3f803f80
  v_mov_b32 v229, 0x3f803f80
  v_mfma_f32_16x16x32_bf16 v[80:83], a[108:111], a[164:167], v[80:83]
  v_mov_b32 v230, 0x3f803f80
  v_mov_b32 v231, 0x3f803f80
  v_mfma_f32_16x16x32_bf16 v[84:87], a[112:115], a[164:167], v[84:87]
  s_add_u32 m0, s84, 6144
  v_lshlrev_b32 v40, 4, v255
  v_mfma_f32_16x16x32_bf16 v[88:91], a[116:119], a[164:167], v[88:91]
  s_waitcnt lgkmcnt(8)
  buffer_store_dwordx4 v[188:191], v40, s[44:47], s57 offen sc1
  v_mfma_f32_16x16x32_bf16 v[92:95], a[120:123], a[164:167], v[92:95]
  buffer_load_dwordx4 v18, s[60:63], s82 offen lds
  buffer_store_dwordx4 v[192:195], v40, s[44:47], s57 offen offset:1024 sc1
  v_mfma_f32_16x16x32_bf16 v[72:75], a[96:99], a[168:171], v[72:75]
  s_waitcnt lgkmcnt(0)
  v_mfma_f32_16x16x32_bf16 v[212:215], v[196:199], v[228:231], 0
  v_mfma_f32_16x16x32_bf16 v[76:79], a[100:103], a[168:171], v[76:79]
  v_mfma_f32_16x16x32_bf16 v[216:219], v[200:203], v[228:231], 0
  v_mfma_f32_16x16x32_bf16 v[80:83], a[104:107], a[168:171], v[80:83]
  v_mfma_f32_16x16x32_bf16 v[220:223], v[204:207], v[228:231], 0
  v_mfma_f32_16x16x32_bf16 v[84:87], a[108:111], a[168:171], v[84:87]
  v_mfma_f32_16x16x32_bf16 v[224:227], v[208:211], v[228:231], 0
  v_lshrrev_b32 v41, 4, v255
  v_lshlrev_b32 v41, 4, v41
  v_mfma_f32_16x16x32_bf16 v[88:91], a[112:115], a[168:171], v[88:91]
  s_lshl_b32 s64, s50, 8
  v_mfma_f32_16x16x32_bf16 v[92:95], a[116:119], a[168:171], v[92:95]
  s_add_u32 s64, s64, 158208
  v_mfma_f32_16x16x32_bf16 v[76:79], a[96:99], a[172:175], v[76:79]
  v_add_u32 v42, s64, v41
  v_mfma_f32_16x16x32_bf16 v[80:83], a[100:103], a[172:175], v[80:83]
  v_lshlrev_b32 v41, 4, v255
  v_mfma_f32_16x16x32_bf16 v[84:87], a[104:107], a[172:175], v[84:87]
  v_add_u32 v43, 158208, v41
  v_mfma_f32_16x16x32_bf16 v[88:91], a[108:111], a[172:175], v[88:91]
  s_lshl_b32 s64, s50, 12
  v_mfma_f32_16x16x32_bf16 v[92:95], a[112:115], a[172:175], v[92:95]
  s_add_u32 s65, s64, 140544
  v_mfma_f32_16x16x32_bf16 v[80:83], a[96:99], a[176:179], v[80:83]
  s_xor_b32 s64, s64, 4096
  v_mfma_f32_16x16x32_bf16 v[84:87], a[100:103], a[176:179], v[84:87]
  s_add_u32 s64, s64, 140544
  v_mfma_f32_16x16x32_bf16 v[88:91], a[104:107], a[176:179], v[88:91]
  v_lshlrev_b32 v8, 4, v255
  v_mfma_f32_16x16x32_bf16 v[92:95], a[108:111], a[176:179], v[92:95]
  v_add_u32 v9, s64, v8
  v_mfma_f32_16x16x32_bf16 v[84:87], a[96:99], a[180:183], v[84:87]
  v_add_u32 v8, s65, v8
  v_mfma_f32_16x16x32_bf16 v[88:91], a[100:103], a[180:183], v[88:91]
  ds_write_b128 v42, v[212:215] offset:0
  v_mfma_f32_16x16x32_bf16 v[92:95], a[104:107], a[180:183], v[92:95]
  ds_write_b128 v42, v[216:219] offset:64
  v_mfma_f32_16x16x32_bf16 v[88:91], a[96:99], a[184:187], v[88:91]
  ds_write_b128 v42, v[220:223] offset:128
  v_mfma_f32_16x16x32_bf16 v[92:95], a[100:103], a[184:187], v[92:95]
  ds_write_b128 v42, v[224:227] offset:192
  v_mfma_f32_16x16x32_bf16 v[92:95], a[96:99], a[188:191], v[92:95]
  s_cmp_lg_u32 s70, 0
  s_cbranch_scc1 L_ex1_14
  s_nop 7
  ds_write_b128 v8, v[80:83] offset:0
  ds_write_b128 v8, v[84:87] offset:1024
  ds_write_b128 v8, v[88:91] offset:2048
  ds_write_b128 v8, v[92:95] offset:3072
  s_waitcnt lgkmcnt(0)
  s_barrier
  ds_read_b128 v[156:159], v9 offset:0
  ds_read_b128 v[160:163], v9 offset:1024
  ds_read_b128 v[164:167], v9 offset:2048
  ds_read_b128 v[168:171], v9 offset:3072
  s_waitcnt lgkmcnt(3)
  v_pk_add_f32 v[140:141], v[64:65], v[156:157]
  v_pk_add_f32 v[142:143], v[66:67], v[158:159]
  s_waitcnt lgkmcnt(2)
  v_pk_add_f32 v[144:145], v[68:69], v[160:161]
  v_pk_add_f32 v[146:147], v[70:71], v[162:163]
  s_waitcnt lgkmcnt(1)
  v_pk_add_f32 v[148:149], v[72:73], v[164:165]
  v_pk_add_f32 v[150:151], v[74:75], v[166:167]
  s_waitcnt lgkmcnt(0)
  v_pk_add_f32 v[152:153], v[76:77], v[168:169]
  v_pk_add_f32 v[154:155], v[78:79], v[170:171]
  s_branch L_ex2_15
L_ex1_14:
  s_nop 7
  ds_write_b128 v8, v[64:67] offset:0
  ds_write_b128 v8, v[68:71] offset:1024
  ds_write_b128 v8, v[72:75] offset:2048
  ds_write_b128 v8, v[76:79] offset:3072
  s_waitcnt lgkmcnt(0)
  s_barrier
  ds_read_b128 v[156:159], v9 offset:0
  ds_read_b128 v[160:163], v9 offset:1024
  ds_read_b128 v[164:167], v9 offset:2048
  ds_read_b128 v[168:171], v9 offset:3072
  s_waitcnt lgkmcnt(3)
  v_pk_add_f32 v[140:141], v[80:81], v[156:157]
  v_pk_add_f32 v[142:143], v[82:83], v[158:159]
  s_waitcnt lgkmcnt(2)
  v_pk_add_f32 v[144:145], v[84:85], v[160:161]
  v_pk_add_f32 v[146:147], v[86:87], v[162:163]
  s_waitcnt lgkmcnt(1)
  v_pk_add_f32 v[148:149], v[88:89], v[164:165]
  v_pk_add_f32 v[150:151], v[90:91], v[166:167]
  s_waitcnt lgkmcnt(0)
  v_pk_add_f32 v[152:153], v[92:93], v[168:169]
  v_pk_add_f32 v[154:155], v[94:95], v[170:171]
L_ex2_15:
  s_waitcnt vmcnt(9)
  v_lshlrev_b32 v156, 16, v100
  v_and_b32 v157, 0xffff0000, v100
  v_lshlrev_b32 v158, 16, v101
  v_and_b32 v159, 0xffff0000, v101
  v_lshlrev_b32 v160, 16, v110
  v_and_b32 v161, 0xffff0000, v110
  v_lshlrev_b32 v162, 16, v111
  v_and_b32 v163, 0xffff0000, v111
  v_lshlrev_b32 v164, 16, v120
  v_and_b32 v165, 0xffff0000, v120
  v_lshlrev_b32 v166, 16, v121
  v_and_b32 v167, 0xffff0000, v121
  v_lshlrev_b32 v168, 16, v130
  v_and_b32 v169, 0xffff0000, v130
  v_lshlrev_b32 v170, 16, v131
  v_and_b32 v171, 0xffff0000, v131
  v_pk_add_f32 v[172:173], v[156:157], v[102:103] neg_lo:[0,1] neg_hi:[0,1]
  v_pk_add_f32 v[174:175], v[158:159], v[104:105] neg_lo:[0,1] neg_hi:[0,1]
  v_pk_add_f32 v[176:177], v[160:161], v[112:113] neg_lo:[0,1] neg_hi:[0,1]
  v_pk_add_f32 v[178:179], v[162:163], v[114:115] neg_lo:[0,1] neg_hi:[0,1]
  v_pk_add_f32 v[180:181], v[164:165], v[122:123] neg_lo:[0,1] neg_hi:[0,1]
  v_pk_add_f32 v[182:183], v[166:167], v[124:125] neg_lo:[0,1] neg_hi:[0,1]
  v_pk_add_f32 v[184:185], v[168:169], v[132:133] neg_lo:[0,1] neg_hi:[0,1]
  v_pk_add_f32 v[186:187], v[170:171], v[134:135] neg_lo:[0,1] neg_hi:[0,1]
  v_pk_mul_f32 v[172:173], v[172:173], v[106:107]
  v_pk_mul_f32 v[174:175], v[174:175], v[108:109]
  v_pk_mul_f32 v[176:177], v[176:177], v[116:117]
  v_pk_mul_f32 v[178:179], v[178:179], v[118:119]
  v_pk_mul_f32 v[180:181], v[180:181], v[126:127]
  v_pk_mul_f32 v[182:183], v[182:183], v[128:129]
  v_pk_mul_f32 v[184:185], v[184:185], v[136:137]
  v_pk_mul_f32 v[186:187], v[186:187], v[138:139]
  v_pk_fma_f32 v[172:173], v[172:173], v[140:141], v[156:157]
  v_pk_fma_f32 v[174:175], v[174:175], v[142:143], v[158:159]
  v_pk_fma_f32 v[176:177], v[176:177], v[144:145], v[160:161]
  v_pk_fma_f32 v[178:179], v[178:179], v[146:147], v[162:163]
  v_pk_fma_f32 v[180:181], v[180:181], v[148:149], v[164:165]
  v_pk_fma_f32 v[182:183], v[182:183], v[150:151], v[166:167]
  v_pk_fma_f32 v[184:185], v[184:185], v[152:153], v[168:169]
  v_pk_fma_f32 v[186:187], v[186:187], v[154:155], v[170:171]
  v_cvt_pk_bf16_f32 v156, v172, v173
  v_cvt_pk_bf16_f32 v157, v174, v175
  v_cvt_pk_bf16_f32 v158, v176, v177
  v_cvt_pk_bf16_f32 v159, v178, v179
  v_cvt_pk_bf16_f32 v160, v180, v181
  v_cvt_pk_bf16_f32 v161, v182, v183
  v_cvt_pk_bf16_f32 v162, v184, v185
  v_cvt_pk_bf16_f32 v163, v186, v187
  buffer_store_dwordx2 v[156:157], v5, s[44:47], s74 offen offset:0 sc1
  buffer_store_dwordx2 v[158:159], v5, s[44:47], s74 offen offset:512 sc1
  buffer_store_dwordx2 v[160:161], v5, s[44:47], s74 offen offset:1024 sc1
  buffer_store_dwordx2 v[162:163], v5, s[44:47], s74 offen offset:1536 sc1
  s_cmp_lg_u32 s50, 1
  s_cbranch_scc1 L_csf_16
  s_bfm_b64 exec, 16, 0
  ds_read_b128 v[188:191], v43
  ds_read_b128 v[192:195], v43 offset:256
  ds_read_b128 v[196:199], v43 offset:512
  ds_read_b128 v[200:203], v43 offset:768
  s_waitcnt lgkmcnt(0)
  v_pk_add_f32 v[188:189], v[188:189], v[192:193]
  v_pk_add_f32 v[190:191], v[190:191], v[194:195]
  v_pk_add_f32 v[188:189], v[188:189], v[196:197]
  v_pk_add_f32 v[190:191], v[190:191], v[198:199]
  v_pk_add_f32 v[188:189], v[188:189], v[200:201]
  v_pk_add_f32 v[190:191], v[190:191], v[202:203]
  buffer_store_dwordx4 v[188:191], v41, s[44:47], s59 offen sc1
  s_mov_b64 exec, -1
  s_waitcnt vmcnt(0)
L_csf_16:
  s_waitcnt vmcnt(0)
  s_barrier
  s_cmp_lg_u32 s50, 0
  s_cbranch_scc1 L_fs_17
  s_lshr_b32 s3, s53, 1
  s_lshl_b32 s3, s3, 7
  s_and_b32 s101, s53, 1
  s_lshl_b32 s101, s101, 6
  s_add_u32 s3, s3, s101
  s_add_u32 s3, s3, 65536
  v_mov_b32 v250, s54
  v_mov_b32 v251, s55
  v_mov_b32 v252, 0
  s_mov_b64 exec, 1
  buffer_store_dwordx2 v[250:251], v252, s[44:47], s3 offen sc1
  s_mov_b64 exec, -1
L_fs_17:
  s_mov_b32 s82, 229376
  s_add_u32 m0, s84, 28688
  s_nop 0
  buffer_load_dwordx4 v12, s[60:63], s82 offen lds
  s_add_u32 m0, s84, 29712
  s_nop 0
  buffer_load_dwordx4 v13, s[60:63], s82 offen lds
  s_add_u32 m0, s84, 30736
  s_nop 0
  buffer_load_dwordx4 v14, s[60:63], s82 offen lds
  s_add_u32 m0, s84, 31760
  s_nop 0
  buffer_load_dwordx4 v15, s[60:63], s82 offen lds
  s_add_u32 m0, s84, 32784
  s_nop 0
  buffer_load_dwordx4 v16, s[60:63], s82 offen lds
  s_add_u32 m0, s84, 33808
  s_nop 0
  buffer_load_dwordx4 v17, s[60:63], s82 offen lds
  s_add_u32 m0, s84, 34832
  s_nop 0
  buffer_load_dwordx4 v18, s[60:63], s82 offen lds
  s_mov_b32 s82, 458752
  s_add_u32 m0, s84, 57376
  s_nop 0
  buffer_load_dwordx4 v12, s[60:63], s82 offen lds
  s_add_u32 m0, s84, 58400
  s_nop 0
  buffer_load_dwordx4 v13, s[60:63], s82 offen lds
  s_add_u32 m0, s84, 59424
  s_nop 0
  buffer_load_dwordx4 v14, s[60:63], s82 offen lds
  s_add_u32 m0, s84, 60448
  s_nop 0
  buffer_load_dwordx4 v15, s[60:63], s82 offen lds
  s_add_u32 m0, s84, 61472
  s_nop 0
  buffer_load_dwordx4 v16, s[60:63], s82 offen lds
  s_add_u32 m0, s84, 62496
  s_nop 0
  buffer_load_dwordx4 v17, s[60:63], s82 offen lds
  s_add_u32 m0, s84, 63520
  s_nop 0
  buffer_load_dwordx4 v18, s[60:63], s82 offen lds
  s_mov_b32 s82, 688128
  s_add_u32 m0, s84, 86064
  s_nop 0
  buffer_load_dwordx4 v12, s[60:63], s82 offen lds
  s_add_u32 m0, s84, 87088
  s_nop 0
  buffer_load_dwordx4 v13, s[60:63], s82 offen lds
  s_add_u32 m0, s84, 88112
  s_nop 0
  buffer_load_dwordx4 v14, s[60:63], s82 offen lds
  s_add_u32 m0, s84, 89136
  s_nop 0
  buffer_load_dwordx4 v15, s[60:63], s82 offen lds
  s_add_u32 m0, s84, 90160
  s_nop 0
  buffer_load_dwordx4 v16, s[60:63], s82 offen lds
  s_add_u32 m0, s84, 91184
  s_nop 0
  buffer_load_dwordx4 v17, s[60:63], s82 offen lds
  s_add_u32 m0, s84, 92208
  s_nop 0
  buffer_load_dwordx4 v18, s[60:63], s82 offen lds
  v_lshrrev_b32 v28, 4, v255
  v_and_b32 v29, 15, v255
  v_lshrrev_b32 v30, 1, v29
  v_and_b32 v29, 1, v29
  s_lshl_b32 s64, s50, 15
  s_lshl_b32 s65, s77, 8
  s_add_u32 s64, s64, s65
  s_lshl_b32 s83, s50, 11
  v_add_u32 v31, 0, v28
  v_xor_b32 v32, v30, v31
  v_lshlrev_b32 v32, 5, v32
  v_lshl_add_u32 v32, v29, 4, v32
  v_lshl_add_u32 v32, v31, 12, v32
  v_add_u32 v10, s64, v32
  v_add_u32 v31, 4, v28
  v_xor_b32 v32, v30, v31
  v_lshlrev_b32 v32, 5, v32
  v_lshl_add_u32 v32, v29, 4, v32
  v_lshl_add_u32 v32, v31, 12, v32
  v_add_u32 v11, s64, v32
  v_bfe_u32 v29, v255, 2, 2
  v_lshl_add_u32 v30, v28, 2, v29
  v_and_b32 v31, 3, v255
  v_and_b32 v32, 7, v30
  v_lshlrev_b32 v33, 8, v30
  v_lshl_add_u32 v33, v31, 3, v33
  v_add_u32 v33, 114944, v33
  s_lshl_b32 s64, s79, 2
  s_lshl_b32 s65, s80, 1
  s_xor_b32 s66, s65, 0
  s_add_u32 s66, s66, s64
  v_xor_b32 v34, s66, v32
  v_lshl_add_u32 v20, v34, 5, v33
  s_xor_b32 s66, s65, 1
  s_add_u32 s66, s66, s64
  v_xor_b32 v34, s66, v32
  v_lshl_add_u32 v21, v34, 5, v33
  s_xor_b32 s66, s65, 2
  s_add_u32 s66, s66, s64
  v_xor_b32 v34, s66, v32
  v_lshl_add_u32 v22, v34, 5, v33
  s_xor_b32 s66, s65, 3
  s_add_u32 s66, s66, s64
  v_xor_b32 v34, s66, v32
  v_lshl_add_u32 v23, v34, 5, v33
  v_mul_u32_u24 v33, 224, v30
  v_and_b32 v34, 1, v31
  v_lshl_add_u32 v33, v34, 3, v33
  v_lshrrev_b32 v34, 1, v31
  v_mul_u32_u24 v34, 14352, v34
  v_add_u32 v33, v33, v34
  s_mul_i32 s64, s80, 112
  s_add_u32 s64, s64, 0
  v_add_u32 v24, s64, v33
  v_add_u32 v25, 57376, v24
  v_lshrrev_b32 v28, 5, v255
  s_lshl_b32 s64, s77, 3
  s_lshl_b32 s65, s79, 2
  s_add_u32 s64, s64, s65
  s_lshl_b32 s65, s80, 1
  s_mul_i32 s66, s78, 14
  s_mul_i32 s67, s80, 7
  s_add_u32 s66, s66, s67
  s_lshl_b32 s66, s66, 8
  v_and_b32 v29, 15, v255
  v_lshlrev_b32 v29, 4, v29
  v_bfe_u32 v30, v255, 4, 1
  v_lshl_add_u32 v29, v30, 3, v29
  v_add_u32 v29, s66, v29
  s_mov_b32 s67, 57344
  v_add_u32 v31, 0, v28
  v_xor_b32 v31, s65, v31
  v_add_u32 v31, s64, v31
  v_mul_lo_u32 v31, s67, v31
  v_add_u32 v240, v31, v29
  v_add_u32 v31, 2, v28
  v_xor_b32 v31, s65, v31
  v_add_u32 v31, s64, v31
  v_mul_lo_u32 v31, s67, v31
  v_add_u32 v241, v31, v29
  s_and_b32 s64, s2, 7
  s_lshr_b32 s65, s2, 3
  s_lshl_b32 s64, s64, 2
  s_and_b32 s66, s65, 3
  s_add_u32 s85, s64, s66
  s_lshr_b32 s86, s65, 2
  s_mul_i32 s87, s50, 458752
  s_lshl_b32 s3, s86, 12
  s_add_u32 s87, s87, s3
  s_add_u32 s87, s87, 7340032
  v_lshlrev_b32 v38, 4, v255
  v_mov_b32 v28, 0x3f803f80
  v_accvgpr_write_b32 a88, v28
  v_accvgpr_write_b32 a89, v28
  v_accvgpr_write_b32 a90, v28
  v_accvgpr_write_b32 a91, v28
  v_lshrrev_b32 v28, 2, v255
  v_and_b32 v29, 3, v255
  v_lshl_add_u32 v28, v28, 4, v29
  s_lshl_b32 s64, s50, 2
  v_add_u32 v29, s64, v28
  v_lshrrev_b32 v28, 1, v29
  v_lshlrev_b32 v28, 7, v28
  v_and_b32 v29, 1, v29
  v_lshl_add_u32 v28, v29, 6, v28
  v_add_u32 v28, 65536, v28
  s_mov_b32 s3, 0
L_poll_18:
  buffer_load_dwordx2 v[236:237], v28, s[44:47], 0 offen sc1
  s_add_u32 s3, s3, 1
  s_waitcnt vmcnt(0)
  v_cmp_ne_u64 vcc, s[54:55], v[236:237]
  s_cmp_ge_u32 s3, 1048576
  s_cbranch_scc1 L_polld_19
  s_nop 0
  s_and_b64 exec, exec, vcc
  s_cbranch_execz L_polld_19
  s_branch L_poll_18
L_polld_19:
  s_mov_b64 exec, -1
  s_add_u32 m0, s83, 114944
  s_mov_b32 s81, 5242880
  buffer_load_dwordx4 v10, s[44:47], s81 offen sc1 lds
  s_add_u32 m0, s83, 115968
  s_mov_b32 s81, 5242880
  buffer_load_dwordx4 v11, s[44:47], s81 offen sc1 lds
  s_add_u32 m0, s83, 123136
  s_mov_b32 s81, 5373952
  buffer_load_dwordx4 v10, s[44:47], s81 offen sc1 lds
  s_add_u32 m0, s83, 124160
  s_mov_b32 s81, 5373952
  buffer_load_dwordx4 v11, s[44:47], s81 offen sc1 lds
  s_add_u32 m0, s83, 131328
  s_mov_b32 s81, 5505024
  buffer_load_dwordx4 v10, s[44:47], s81 offen sc1 lds
  s_add_u32 m0, s83, 132352
  s_mov_b32 s81, 5505024
  buffer_load_dwordx4 v11, s[44:47], s81 offen sc1 lds
  s_add_u32 m0, s83, 139520
  s_mov_b32 s81, 5636096
  buffer_load_dwordx4 v10, s[44:47], s81 offen sc1 lds
  s_add_u32 m0, s83, 140544
  s_mov_b32 s81, 5636096
  buffer_load_dwordx4 v11, s[44:47], s81 offen sc1 lds
  s_add_u32 m0, s83, 147712
  s_mov_b32 s81, 5767168
  buffer_load_dwordx4 v10, s[44:47], s81 offen sc1 lds
  s_add_u32 m0, s83, 148736
  s_mov_b32 s81, 5767168
  buffer_load_dwordx4 v11, s[44:47], s81 offen sc1 lds
  ds_read_b64_tr_b16 a[0:1], v24 offset:0
  ds_read_b64_tr_b16 a[4:5], v24 offset:16
  ds_read_b64_tr_b16 a[8:9], v24 offset:32
  ds_read_b64_tr_b16 a[12:13], v24 offset:48
  ds_read_b64_tr_b16 a[16:17], v24 offset:64
  ds_read_b64_tr_b16 a[20:21], v24 offset:80
  ds_read_b64_tr_b16 a[24:25], v24 offset:96
  ds_read_b64_tr_b16 a[2:3], v24 offset:3584
  ds_read_b64_tr_b16 a[6:7], v24 offset:3600
  ds_read_b64_tr_b16 a[10:11], v24 offset:3616
  ds_read_b64_tr_b16 a[14:15], v24 offset:3632
  ds_read_b64_tr_b16 a[18:19], v24 offset:3648
  ds_read_b64_tr_b16 a[22:23], v24 offset:3664
  ds_read_b64_tr_b16 a[26:27], v24 offset:3680
  s_waitcnt vmcnt(8)
  s_barrier
  ds_read_b64_tr_b16 a[56:57], v20 offset:0
  ds_read_b64_tr_b16 a[60:61], v21 offset:0
  ds_read_b64_tr_b16 a[64:65], v22 offset:0
  ds_read_b64_tr_b16 a[68:69], v23 offset:0
  ds_read_b64_tr_b16 a[58:59], v20 offset:4096
  ds_read_b64_tr_b16 a[62:63], v21 offset:4096
  ds_read_b64_tr_b16 a[66:67], v22 offset:4096
  ds_read_b64_tr_b16 a[70:71], v23 offset:4096
  s_waitcnt vmcnt(6)
  s_waitcnt lgkmcnt(0)
  s_barrier
  v_mfma_f32_16x16x32_bf16 v[128:131], a[0:3], a[56:59], 0
  s_mov_b32 s81, 5898240
  ds_read_b64_tr_b16 a[72:73], v20 offset:8192
  v_mfma_f32_16x16x32_bf16 v[132:135], a[4:7], a[56:59], 0
  s_add_u32 m0, s83, 114944
  ds_read_b64_tr_b16 a[76:77], v21 offset:8192
  v_mfma_f32_16x16x32_bf16 v[136:139], a[8:11], a[56:59], 0
  buffer_load_dwordx4 v10, s[44:47], s81 offen sc1 lds
  v_mfma_f32_16x16x32_bf16 v[140:143], a[12:15], a[56:59], 0
  ds_read_b64_tr_b16 a[80:81], v22 offset:8192
  s_add_u32 m0, s83, 115968
  v_mfma_f32_16x16x32_bf16 v[144:147], a[16:19], a[56:59], 0
  ds_read_b64_tr_b16 a[84:85], v23 offset:8192
  v_mfma_f32_16x16x32_bf16 v[148:151], a[20:23], a[56:59], 0
  buffer_load_dwordx4 v11, s[44:47], s81 offen sc1 lds
  ds_read_b64_tr_b16 a[28:29], v24 offset:7168
  v_mfma_f32_16x16x32_bf16 v[152:155], a[24:27], a[56:59], 0
  v_min_u32 v30, 223, v243
  ds_read_b64_tr_b16 a[32:33], v24 offset:7184
  v_mfma_f32_16x16x32_bf16 v[112:115], a[88:91], a[56:59], 0
  v_cmp_le_u32 vcc, 112, v30
  v_mfma_f32_16x16x32_bf16 v[120:123], a[56:59], a[56:59], 0
  ds_read_b64_tr_b16 a[36:37], v24 offset:7200
  v_mov_b32 v31, 0
  v_mfma_f32_16x16x32_bf16 v[156:159], a[0:3], a[60:63], 0
  ds_read_b64_tr_b16 a[40:41], v24 offset:7216
  v_mfma_f32_16x16x32_bf16 v[160:163], a[4:7], a[60:63], 0
  v_mov_b32 v32, 1680
  ds_read_b64_tr_b16 a[44:45], v24 offset:7232
  v_mfma_f32_16x16x32_bf16 v[164:167], a[8:11], a[60:63], 0
  v_cndmask_b32 v31, v31, v32, vcc
  ds_read_b64_tr_b16 a[48:49], v24 offset:7248
  v_mfma_f32_16x16x32_bf16 v[168:171], a[12:15], a[60:63], 0
  v_add_u32 v31, v31, v30
  v_mfma_f32_16x16x32_bf16 v[172:175], a[16:19], a[60:63], 0
  ds_read_b64_tr_b16 a[52:53], v24 offset:7264
  s_mul_i32 s66, s78, 112
  v_mfma_f32_16x16x32_bf16 v[176:179], a[20:23], a[60:63], 0
  v_add_u32 v31, s66, v31
  v_mfma_f32_16x16x32_bf16 v[180:183], a[24:27], a[60:63], 0
  ds_read_b64_tr_b16 a[74:75], v20 offset:12288
  v_lshlrev_b32 v31, 2, v31
  v_mfma_f32_16x16x32_bf16 v[116:119], a[88:91], a[60:63], 0
  ds_read_b64_tr_b16 a[78:79], v21 offset:12288
  v_mfma_f32_16x16x32_bf16 v[124:127], a[60:63], a[60:63], 0
  v_lshlrev_b32 v30, 2, v30
  ds_read_b64_tr_b16 a[82:83], v22 offset:12288
  v_mfma_f32_16x16x32_bf16 v[184:187], a[0:3], a[64:67], 0
  v_add_u32 v30, 159232, v30
  ds_read_b64_tr_b16 a[86:87], v23 offset:12288
  v_mfma_f32_16x16x32_bf16 v[188:191], a[4:7], a[64:67], 0
  s_mov_b32 s66, 147456
  v_mfma_f32_16x16x32_bf16 v[192:195], a[8:11], a[64:67], 0
  ds_read_b64_tr_b16 a[30:31], v24 offset:10752
  buffer_load_dword v32, v31, s[44:47], s66 offen sc1
  v_mfma_f32_16x16x32_bf16 v[196:199], a[12:15], a[64:67], 0
  ds_read_b64_tr_b16 a[34:35], v24 offset:10768
  v_mfma_f32_16x16x32_bf16 v[200:203], a[16:19], a[64:67], 0
  s_add_u32 s66, s66, 14336
  ds_read_b64_tr_b16 a[38:39], v24 offset:10784
  v_mfma_f32_16x16x32_bf16 v[204:207], a[20:23], a[64:67], 0
  buffer_load_dword v33, v31, s[44:47], s66 offen sc1
  ds_read_b64_tr_b16 a[42:43], v24 offset:10800
  v_mfma_f32_16x16x32_bf16 v[208:211], a[24:27], a[64:67], 0
  s_add_u32 s66, s66, 14336
  v_mfma_f32_16x16x32_bf16 v[212:215], a[0:3], a[68:71], 0
  ds_read_b64_tr_b16 a[46:47], v24 offset:10816
  buffer_load_dword v34, v31, s[44:47], s66 offen sc1
  v_mfma_f32_16x16x32_bf16 v[216:219], a[4:7], a[68:71], 0
  ds_read_b64_tr_b16 a[50:51], v24 offset:10832
  v_mfma_f32_16x16x32_bf16 v[220:223], a[8:11], a[68:71], 0
  s_add_u32 s66, s66, 14336
  ds_read_b64_tr_b16 a[54:55], v24 offset:10848
  v_mfma_f32_16x16x32_bf16 v[224:227], a[12:15], a[68:71], 0
  buffer_load_dword v35, v31, s[44:47], s66 offen sc1
  v_mfma_f32_16x16x32_bf16 v[228:231], a[16:19], a[68:71], 0
  v_mfma_f32_16x16x32_bf16 v[232:235], a[20:23], a[68:71], 0
  v_mfma_f32_16x16x32_bf16 v[236:239], a[24:27], a[68:71], 0
  s_waitcnt vmcnt(10)
  s_waitcnt lgkmcnt(0)
  s_barrier
  v_mfma_f32_16x16x32_bf16 v[128:131], a[28:31], a[72:75], v[128:131]
  ds_read_b64_tr_b16 a[56:57], v20 offset:16384
  s_mov_b32 s81, 6029312
  v_mfma_f32_16x16x32_bf16 v[132:135], a[32:35], a[72:75], v[132:135]
  ds_read_b64_tr_b16 a[60:61], v21 offset:16384
  v_mfma_f32_16x16x32_bf16 v[136:139], a[36:39], a[72:75], v[136:139]
  s_add_u32 m0, s83, 123136
  v_mfma_f32_16x16x32_bf16 v[140:143], a[40:43], a[72:75], v[140:143]
  ds_read_b64_tr_b16 a[64:65], v22 offset:16384
  v_mfma_f32_16x16x32_bf16 v[144:147], a[44:47], a[72:75], v[144:147]
  ds_read_b64_tr_b16 a[68:69], v23 offset:16384
  buffer_load_dwordx4 v10, s[44:47], s81 offen sc1 lds
  v_mfma_f32_16x16x32_bf16 v[148:151], a[48:51], a[72:75], v[148:151]
  ds_read_b64_tr_b16 a[0:1], v24 offset:28688
  v_mfma_f32_16x16x32_bf16 v[152:155], a[52:55], a[72:75], v[152:155]
  ds_read_b64_tr_b16 a[4:5], v24 offset:28704
  v_mfma_f32_16x16x32_bf16 v[112:115], a[88:91], a[72:75], v[112:115]
  s_add_u32 m0, s83, 124160
  v_mfma_f32_16x16x32_bf16 v[120:123], a[72:75], a[72:75], v[120:123]
  ds_read_b64_tr_b16 a[8:9], v24 offset:28720
  buffer_load_dwordx4 v11, s[44:47], s81 offen sc1 lds
  v_mfma_f32_16x16x32_bf16 v[156:159], a[28:31], a[76:79], v[156:159]
  ds_read_b64_tr_b16 a[12:13], v24 offset:28736
  v_mfma_f32_16x16x32_bf16 v[160:163], a[32:35], a[76:79], v[160:163]
  ds_read_b64_tr_b16 a[16:17], v24 offset:28752
  v_mfma_f32_16x16x32_bf16 v[164:167], a[36:39], a[76:79], v[164:167]
  s_mov_b32 s82, 917504
  v_mfma_f32_16x16x32_bf16 v[168:171], a[40:43], a[76:79], v[168:171]
  ds_read_b64_tr_b16 a[20:21], v24 offset:28768
  s_add_u32 m0, s84, 0
  v_mfma_f32_16x16x32_bf16 v[172:175], a[44:47], a[76:79], v[172:175]
  ds_read_b64_tr_b16 a[24:25], v24 offset:28784
  v_mfma_f32_16x16x32_bf16 v[176:179], a[48:51], a[76:79], v[176:179]
  ds_read_b64_tr_b16 a[58:59], v20 offset:20480
  v_mfma_f32_16x16x32_bf16 v[180:183], a[52:55], a[76:79], v[180:183]
  buffer_load_dwordx4 v12, s[60:63], s82 offen lds
  v_mfma_f32_16x16x32_bf16 v[116:119], a[88:91], a[76:79], v[116:119]
  ds_read_b64_tr_b16 a[62:63], v21 offset:20480
  s_add_u32 m0, s84, 1024
  v_mfma_f32_16x16x32_bf16 v[124:127], a[76:79], a[76:79], v[124:127]
  ds_read_b64_tr_b16 a[66:67], v22 offset:20480
  v_mfma_f32_16x16x32_bf16 v[184:187], a[28:31], a[80:83], v[184:187]
  ds_read_b64_tr_b16 a[70:71], v23 offset:20480
  v_mfma_f32_16x16x32_bf16 v[188:191], a[32:35], a[80:83], v[188:191]
  buffer_load_dwordx4 v13, s[60:63], s82 offen lds
  v_mfma_f32_16x16x32_bf16 v[192:195], a[36:39], a[80:83], v[192:195]
  ds_read_b64_tr_b16 a[2:3], v24 offset:32272
  ds_read_b64_tr_b16 a[6:7], v24 offset:32288
  v_mfma_f32_16x16x32_bf16 v[196:199], a[40:43], a[80:83], v[196:199]
  s_add_u32 m0, s84, 2048
  v_mfma_f32_16x16x32_bf16 v[200:203], a[44:47], a[80:83], v[200:203]
  ds_read_b64_tr_b16 a[10:11], v24 offset:32304
  v_mfma_f32_16x16x32_bf16 v[204:207], a[48:51], a[80:83], v[204:207]
  buffer_load_dwordx4 v14, s[60:63], s82 offen lds
  v_mfma_f32_16x16x32_bf16 v[208:211], a[52:55], a[80:83], v[208:211]
  ds_read_b64_tr_b16 a[14:15], v24 offset:32320
  ds_read_b64_tr_b16 a[18:19], v24 offset:32336
  v_mfma_f32_16x16x32_bf16 v[212:215], a[28:31], a[84:87], v[212:215]
  s_add_u32 m0, s84, 3072
  v_mfma_f32_16x16x32_bf16 v[216:219], a[32:35], a[84:87], v[216:219]
  ds_read_b64_tr_b16 a[22:23], v24 offset:32352
  v_mfma_f32_16x16x32_bf16 v[220:223], a[36:39], a[84:87], v[220:223]
  buffer_load_dwordx4 v15, s[60:63], s82 offen lds
  v_mfma_f32_16x16x32_bf16 v[224:227], a[40:43], a[84:87], v[224:227]
  ds_read_b64_tr_b16 a[26:27], v24 offset:32368
  v_mfma_f32_16x16x32_bf16 v[228:231], a[44:47], a[84:87], v[228:231]
  v_mfma_f32_16x16x32_bf16 v[232:235], a[48:51], a[84:87], v[232:235]
  v_mfma_f32_16x16x32_bf16 v[236:239], a[52:55], a[84:87], v[236:239]
  s_waitcnt vmcnt(14)
  s_waitcnt lgkmcnt(0)
  s_barrier
  v_mfma_f32_16x16x32_bf16 v[128:131], a[0:3], a[56:59], v[128:131]
  ds_read_b64_tr_b16 a[72:73], v20 offset:24576
  s_mov_b32 s81, 6160384
  v_mfma_f32_16x16x32_bf16 v[132:135], a[4:7], a[56:59], v[132:135]
  ds_read_b64_tr_b16 a[76:77], v21 offset:24576
  v_mfma_f32_16x16x32_bf16 v[136:139], a[8:11], a[56:59], v[136:139]
  ds_read_b64_tr_b16 a[80:81], v22 offset:24576
  v_mfma_f32_16x16x32_bf16 v[140:143], a[12:15], a[56:59], v[140:143]
  s_add_u32 m0, s83, 131328
  v_mfma_f32_16x16x32_bf16 v[144:147], a[16:19], a[56:59], v[144:147]
  ds_read_b64_tr_b16 a[84:85], v23 offset:24576
  v_mfma_f32_16x16x32_bf16 v[148:151], a[20:23], a[56:59], v[148:151]
  ds_read_b64_tr_b16 a[28:29], v24 offset:35856
  v_mfma_f32_16x16x32_bf16 v[152:155], a[24:27], a[56:59], v[152:155]
  buffer_load_dwordx4 v10, s[44:47], s81 offen sc1 lds
  v_mfma_f32_16x16x32_bf16 v[112:115], a[88:91], a[56:59], v[112:115]
  ds_read_b64_tr_b16 a[32:33], v24 offset:35872
  ds_read_b64_tr_b16 a[36:37], v24 offset:35888
  v_mfma_f32_16x16x32_bf16 v[120:123], a[56:59], a[56:59], v[120:123]
  s_add_u32 m0, s83, 132352
  v_mfma_f32_16x16x32_bf16 v[156:159], a[0:3], a[60:63], v[156:159]
  ds_read_b64_tr_b16 a[40:41], v24 offset:35904
  v_mfma_f32_16x16x32_bf16 v[160:163], a[4:7], a[60:63], v[160:163]
  ds_read_b64_tr_b16 a[44:45], v24 offset:35920
  v_mfma_f32_16x16x32_bf16 v[164:167], a[8:11], a[60:63], v[164:167]
  buffer_load_dwordx4 v11, s[44:47], s81 offen sc1 lds
  v_mfma_f32_16x16x32_bf16 v[168:171], a[12:15], a[60:63], v[168:171]
  ds_read_b64_tr_b16 a[48:49], v24 offset:35936
  v_mfma_f32_16x16x32_bf16 v[172:175], a[16:19], a[60:63], v[172:175]
  ds_read_b64_tr_b16 a[52:53], v24 offset:35952
  v_mfma_f32_16x16x32_bf16 v[176:179], a[20:23], a[60:63], v[176:179]
  s_add_u32 m0, s84, 4096
  ds_read_b64_tr_b16 a[74:75], v20 offset:28672
  v_mfma_f32_16x16x32_bf16 v[180:183], a[24:27], a[60:63], v[180:183]
  ds_read_b64_tr_b16 a[78:79], v21 offset:28672
  v_mfma_f32_16x16x32_bf16 v[116:119], a[88:91], a[60:63], v[116:119]
  buffer_load_dwordx4 v16, s[60:63], s82 offen lds
  v_mfma_f32_16x16x32_bf16 v[124:127], a[60:63], a[60:63], v[124:127]
  ds_read_b64_tr_b16 a[82:83], v22 offset:28672
  v_mfma_f32_16x16x32_bf16 v[184:187], a[0:3], a[64:67], v[184:187]
  ds_read_b64_tr_b16 a[86:87], v23 offset:28672
  v_mfma_f32_16x16x32_bf16 v[188:191], a[4:7], a[64:67], v[188:191]
  s_add_u32 m0, s84, 5120
  v_mfma_f32_16x16x32_bf16 v[192:195], a[8:11], a[64:67], v[192:195]
  ds_read_b64_tr_b16 a[30:31], v24 offset:39440
  v_mfma_f32_16x16x32_bf16 v[196:199], a[12:15], a[64:67], v[196:199]
  ds_read_b64_tr_b16 a[34:35], v24 offset:39456
  buffer_load_dwordx4 v17, s[60:63], s82 offen lds
  v_mfma_f32_16x16x32_bf16 v[200:203], a[16:19], a[64:67], v[200:203]
  ds_read_b64_tr_b16 a[38:39], v24 offset:39472
  v_mfma_f32_16x16x32_bf16 v[204:207], a[20:23], a[64:67], v[204:207]
  ds_read_b64_tr_b16 a[42:43], v24 offset:39488
  v_mfma_f32_16x16x32_bf16 v[208:211], a[24:27], a[64:67], v[208:211]
  s_add_u32 m0, s84, 6144
  v_mfma_f32_16x16x32_bf16 v[212:215], a[0:3], a[68:71], v[212:215]
  ds_read_b64_tr_b16 a[46:47], v24 offset:39504
  v_mfma_f32_16x16x32_bf16 v[216:219], a[4:7], a[68:71], v[216:219]
  ds_read_b64_tr_b16 a[50:51], v24 offset:39520
  v_mfma_f32_16x16x32_bf16 v[220:223], a[8:11], a[68:71], v[220:223]
  buffer_load_dwordx4 v18, s[60:63], s82 offen lds
  v_mfma_f32_16x16x32_bf16 v[224:227], a[12:15], a[68:71], v[224:227]
  ds_read_b64_tr_b16 a[54:55], v24 offset:39536
  v_mfma_f32_16x16x32_bf16 v[228:231], a[16:19], a[68:71], v[228:231]
  v_mfma_f32_16x16x32_bf16 v[232:235], a[20:23], a[68:71], v[232:235]
  v_mfma_f32_16x16x32_bf16 v[236:239], a[24:27], a[68:71], v[236:239]
  s_waitcnt vmcnt(17)
  s_waitcnt lgkmcnt(0)
  s_barrier
  v_mfma_f32_16x16x32_bf16 v[128:131], a[28:31], a[72:75], v[128:131]
  ds_read_b64_tr_b16 a[56:57], v20 offset:32768
  s_mov_b32 s81, 6291456
  v_mfma_f32_16x16x32_bf16 v[132:135], a[32:35], a[72:75], v[132:135]
  ds_read_b64_tr_b16 a[60:61], v21 offset:32768
  v_mfma_f32_16x16x32_bf16 v[136:139], a[36:39], a[72:75], v[136:139]
  s_add_u32 m0, s83, 139520
  ds_read_b64_tr_b16 a[64:65], v22 offset:32768
  v_mfma_f32_16x16x32_bf16 v[140:143], a[40:43], a[72:75], v[140:143]
  buffer_load_dwordx4 v10, s[44:47], s81 offen sc1 lds
  v_mfma_f32_16x16x32_bf16 v[144:147], a[44:47], a[72:75], v[144:147]
  ds_read_b64_tr_b16 a[68:69], v23 offset:32768
  s_add_u32 m0, s83, 140544
  v_mfma_f32_16x16x32_bf16 v[148:151], a[48:51], a[72:75], v[148:151]
  ds_read_b64_tr_b16 a[0:1], v25 offset:0
  v_mfma_f32_16x16x32_bf16 v[152:155], a[52:55], a[72:75], v[152:155]
  buffer_load_dwordx4 v11, s[44:47], s81 offen sc1 lds
  v_mfma_f32_16x16x32_bf16 v[112:115], a[88:91], a[72:75], v[112:115]
  ds_read_b64_tr_b16 a[4:5], v25 offset:16
  s_mov_b32 s82, 1146880
  v_mfma_f32_16x16x32_bf16 v[120:123], a[72:75], a[72:75], v[120:123]
  ds_read_b64_tr_b16 a[8:9], v25 offset:32
  v_mfma_f32_16x16x32_bf16 v[156:159], a[28:31], a[76:79], v[156:159]
  ds_read_b64_tr_b16 a[12:13], v25 offset:48
  s_add_u32 m0, s84, 28688
  v_mfma_f32_16x16x32_bf16 v[160:163], a[32:35], a[76:79], v[160:163]
  ds_read_b64_tr_b16 a[16:17], v25 offset:64
  v_mfma_f32_16x16x32_bf16 v[164:167], a[36:39], a[76:79], v[164:167]
  buffer_load_dwordx4 v12, s[60:63], s82 offen lds
  v_mfma_f32_16x16x32_bf16 v[168:171], a[40:43], a[76:79], v[168:171]
  ds_read_b64_tr_b16 a[20:21], v25 offset:80
  s_add_u32 m0, s84, 29712
  v_mfma_f32_16x16x32_bf16 v[172:175], a[44:47], a[76:79], v[172:175]
  ds_read_b64_tr_b16 a[24:25], v25 offset:96
  v_mfma_f32_16x16x32_bf16 v[176:179], a[48:51], a[76:79], v[176:179]
  buffer_load_dwordx4 v13, s[60:63], s82 offen lds
  ds_read_b64_tr_b16 a[58:59], v20 offset:36864
  v_mfma_f32_16x16x32_bf16 v[180:183], a[52:55], a[76:79], v[180:183]
  s_add_u32 m0, s84, 30736
  v_mfma_f32_16x16x32_bf16 v[116:119], a[88:91], a[76:79], v[116:119]
  ds_read_b64_tr_b16 a[62:63], v21 offset:36864
  buffer_load_dwordx4 v14, s[60:63], s82 offen lds
  v_mfma_f32_16x16x32_bf16 v[124:127], a[76:79], a[76:79], v[124:127]
  ds_read_b64_tr_b16 a[66:67], v22 offset:36864
  v_mfma_f32_16x16x32_bf16 v[184:187], a[28:31], a[80:83], v[184:187]
  s_add_u32 m0, s84, 31760
  v_mfma_f32_16x16x32_bf16 v[188:191], a[32:35], a[80:83], v[188:191]
  ds_read_b64_tr_b16 a[70:71], v23 offset:36864
  ds_read_b64_tr_b16 a[2:3], v25 offset:3584
  v_mfma_f32_16x16x32_bf16 v[192:195], a[36:39], a[80:83], v[192:195]
  buffer_load_dwordx4 v15, s[60:63], s82 offen lds
  v_mfma_f32_16x16x32_bf16 v[196:199], a[40:43], a[80:83], v[196:199]
  ds_read_b64_tr_b16 a[6:7], v25 offset:3600
  s_waitcnt vmcnt(17)
  v_mfma_f32_16x16x32_bf16 v[200:203], a[44:47], a[80:83], v[200:203]
  ds_read_b64_tr_b16 a[10:11], v25 offset:3616
  v_mfma_f32_16x16x32_bf16 v[204:207], a[48:51], a[80:83], v[204:207]
  v_add_f32 v32, v32, v33
  v_mfma_f32_16x16x32_bf16 v[208:211], a[52:55], a[80:83], v[208:211]
  ds_read_b64_tr_b16 a[14:15], v25 offset:3632
  v_add_f32 v34, v34, v35
  v_mfma_f32_16x16x32_bf16 v[212:215], a[28:31], a[84:87], v[212:215]
  ds_read_b64_tr_b16 a[18:19], v25 offset:3648
  v_mfma_f32_16x16x32_bf16 v[216:219], a[32:35], a[84:87], v[216:219]
  v_add_f32 v32, v32, v34
  ds_read_b64_tr_b16 a[22:23], v25 offset:3664
  v_mfma_f32_16x16x32_bf16 v[220:223], a[36:39], a[84:87], v[220:223]
  ds_write_b32 v30, v32
  v_mfma_f32_16x16x32_bf16 v[224:227], a[40:43], a[84:87], v[224:227]
  ds_read_b64_tr_b16 a[26:27], v25 offset:3680
  v_mfma_f32_16x16x32_bf16 v[228:231], a[44:47], a[84:87], v[228:231]
  v_mfma_f32_16x16x32_bf16 v[232:235], a[48:51], a[84:87], v[232:235]
  v_mfma_f32_16x16x32_bf16 v[236:239], a[52:55], a[84:87], v[236:239]
  s_waitcnt lgkmcnt(0)
  s_barrier
  v_mfma_f32_16x16x32_bf16 v[128:131], a[0:3], a[56:59], v[128:131]
  ds_read_b64_tr_b16 a[72:73], v20 offset:0
  s_mov_b32 s81, 6422528
  v_mfma_f32_16x16x32_bf16 v[132:135], a[4:7], a[56:59], v[132:135]
  ds_read_b64_tr_b16 a[76:77], v21 offset:0
  v_mfma_f32_16x16x32_bf16 v[136:139], a[8:11], a[56:59], v[136:139]
  ds_read_b64_tr_b16 a[80:81], v22 offset:0
  v_mfma_f32_16x16x32_bf16 v[140:143], a[12:15], a[56:59], v[140:143]
  s_add_u32 m0, s83, 147712
  v_mfma_f32_16x16x32_bf16 v[144:147], a[16:19], a[56:59], v[144:147]
  ds_read_b64_tr_b16 a[84:85], v23 offset:0
  v_mfma_f32_16x16x32_bf16 v[148:151], a[20:23], a[56:59], v[148:151]
  ds_read_b64_tr_b16 a[28:29], v25 offset:7168
  v_mfma_f32_16x16x32_bf16 v[152:155], a[24:27], a[56:59], v[152:155]
  buffer_load_dwordx4 v10, s[44:47], s81 offen sc1 lds
  v_mfma_f32_16x16x32_bf16 v[112:115], a[88:91], a[56:59], v[112:115]
  ds_read_b64_tr_b16 a[32:33], v25 offset:7184
  ds_read_b64_tr_b16 a[36:37], v25 offset:7200
  v_mfma_f32_16x16x32_bf16 v[120:123], a[56:59], a[56:59], v[120:123]
  s_add_u32 m0, s83, 148736
  v_mfma_f32_16x16x32_bf16 v[156:159], a[0:3], a[60:63], v[156:159]
  ds_read_b64_tr_b16 a[40:41], v25 offset:7216
  v_mfma_f32_16x16x32_bf16 v[160:163], a[4:7], a[60:63], v[160:163]
  ds_read_b64_tr_b16 a[44:45], v25 offset:7232
  v_mfma_f32_16x16x32_bf16 v[164:167], a[8:11], a[60:63], v[164:167]
  buffer_load_dwordx4 v11, s[44:47], s81 offen sc1 lds
  v_mfma_f32_16x16x32_bf16 v[168:171], a[12:15], a[60:63], v[168:171]
  ds_read_b64_tr_b16 a[48:49], v25 offset:7248
  v_mfma_f32_16x16x32_bf16 v[172:175], a[16:19], a[60:63], v[172:175]
  ds_read_b64_tr_b16 a[52:53], v25 offset:7264
  v_mfma_f32_16x16x32_bf16 v[176:179], a[20:23], a[60:63], v[176:179]
  s_add_u32 m0, s84, 32784
  ds_read_b64_tr_b16 a[74:75], v20 offset:4096
  v_mfma_f32_16x16x32_bf16 v[180:183], a[24:27], a[60:63], v[180:183]
  ds_read_b64_tr_b16 a[78:79], v21 offset:4096
  v_mfma_f32_16x16x32_bf16 v[116:119], a[88:91], a[60:63], v[116:119]
  buffer_load_dwordx4 v16, s[60:63], s82 offen lds
  v_mfma_f32_16x16x32_bf16 v[124:127], a[60:63], a[60:63], v[124:127]
  ds_read_b64_tr_b16 a[82:83], v22 offset:4096
  v_mfma_f32_16x16x32_bf16 v[184:187], a[0:3], a[64:67], v[184:187]
  ds_read_b64_tr_b16 a[86:87], v23 offset:4096
  v_mfma_f32_16x16x32_bf16 v[188:191], a[4:7], a[64:67], v[188:191]
  s_add_u32 m0, s84, 33808
  v_mfma_f32_16x16x32_bf16 v[192:195], a[8:11], a[64:67], v[192:195]
  ds_read_b64_tr_b16 a[30:31], v25 offset:10752
  v_mfma_f32_16x16x32_bf16 v[196:199], a[12:15], a[64:67], v[196:199]
  ds_read_b64_tr_b16 a[34:35], v25 offset:10768
  buffer_load_dwordx4 v17, s[60:63], s82 offen lds
  v_mfma_f32_16x16x32_bf16 v[200:203], a[16:19], a[64:67], v[200:203]
  ds_read_b64_tr_b16 a[38:39], v25 offset:10784
  v_mfma_f32_16x16x32_bf16 v[204:207], a[20:23], a[64:67], v[204:207]
  ds_read_b64_tr_b16 a[42:43], v25 offset:10800
  v_mfma_f32_16x16x32_bf16 v[208:211], a[24:27], a[64:67], v[208:211]
  s_add_u32 m0, s84, 34832
  v_mfma_f32_16x16x32_bf16 v[212:215], a[0:3], a[68:71], v[212:215]
  ds_read_b64_tr_b16 a[46:47], v25 offset:10816
  v_mfma_f32_16x16x32_bf16 v[216:219], a[4:7], a[68:71], v[216:219]
  ds_read_b64_tr_b16 a[50:51], v25 offset:10832
  v_mfma_f32_16x16x32_bf16 v[220:223], a[8:11], a[68:71], v[220:223]
  buffer_load_dwordx4 v18, s[60:63], s82 offen lds
  v_mfma_f32_16x16x32_bf16 v[224:227], a[12:15], a[68:71], v[224:227]
  ds_read_b64_tr_b16 a[54:55], v25 offset:10848
  v_mfma_f32_16x16x32_bf16 v[228:231], a[16:19], a[68:71], v[228:231]
  v_mfma_f32_16x16x32_bf16 v[232:235], a[20:23], a[68:71], v[232:235]
  v_mfma_f32_16x16x32_bf16 v[236:239], a[24:27], a[68:71], v[236:239]
  s_waitcnt vmcnt(20)
  s_waitcnt lgkmcnt(0)
  s_barrier
  v_mfma_f32_16x16x32_bf16 v[128:131], a[28:31], a[72:75], v[128:131]
  ds_read_b64_tr_b16 a[56:57], v20 offset:8192
  s_mov_b32 s81, 6553600
  v_mfma_f32_16x16x32_bf16 v[132:135], a[32:35], a[72:75], v[132:135]
  ds_read_b64_tr_b16 a[60:61], v21 offset:8192
  v_mfma_f32_16x16x32_bf16 v[136:139], a[36:39], a[72:75], v[136:139]
  s_add_u32 m0, s83, 114944
  v_mfma_f32_16x16x32_bf16 v[140:143], a[40:43], a[72:75], v[140:143]
  ds_read_b64_tr_b16 a[64:65], v22 offset:8192
  v_mfma_f32_16x16x32_bf16 v[144:147], a[44:47], a[72:75], v[144:147]
  ds_read_b64_tr_b16 a[68:69], v23 offset:8192
  buffer_load_dwordx4 v10, s[44:47], s81 offen sc1 lds
  v_mfma_f32_16x16x32_bf16 v[148:151], a[48:51], a[72:75], v[148:151]
  ds_read_b64_tr_b16 a[0:1], v25 offset:28688
  v_mfma_f32_16x16x32_bf16 v[152:155], a[52:55], a[72:75], v[152:155]
  ds_read_b64_tr_b16 a[4:5], v25 offset:28704
  v_mfma_f32_16x16x32_bf16 v[112:115], a[88:91], a[72:75], v[112:115]
  s_add_u32 m0, s83, 115968
  v_mfma_f32_16x16x32_bf16 v[120:123], a[72:75], a[72:75], v[120:123]
  ds_read_b64_tr_b16 a[8:9], v25 offset:28720
  buffer_load_dwordx4 v11, s[44:47], s81 offen sc1 lds
  v_mfma_f32_16x16x32_bf16 v[156:159], a[28:31], a[76:79], v[156:159]
  ds_read_b64_tr_b16 a[12:13], v25 offset:28736
  v_mfma_f32_16x16x32_bf16 v[160:163], a[32:35], a[76:79], v[160:163]
  ds_read_b64_tr_b16 a[16:17], v25 offset:28752
  v_mfma_f32_16x16x32_bf16 v[164:167], a[36:39], a[76:79], v[164:167]
  s_mov_b32 s82, 1376256
  v_mfma_f32_16x16x32_bf16 v[168:171], a[40:43], a[76:79], v[168:171]
  ds_read_b64_tr_b16 a[20:21], v25 offset:28768
  s_add_u32 m0, s84, 57376
  v_mfma_f32_16x16x32_bf16 v[172:175], a[44:47], a[76:79], v[172:175]
  ds_read_b64_tr_b16 a[24:25], v25 offset:28784
  v_mfma_f32_16x16x32_bf16 v[176:179], a[48:51], a[76:79], v[176:179]
  ds_read_b64_tr_b16 a[58:59], v20 offset:12288
  v_mfma_f32_16x16x32_bf16 v[180:183], a[52:55], a[76:79], v[180:183]
  buffer_load_dwordx4 v12, s[60:63], s82 offen lds
  v_mfma_f32_16x16x32_bf16 v[116:119], a[88:91], a[76:79], v[116:119]
  ds_read_b64_tr_b16 a[62:63], v21 offset:12288
  s_add_u32 m0, s84, 58400
  v_mfma_f32_16x16x32_bf16 v[124:127], a[76:79], a[76:79], v[124:127]
  ds_read_b64_tr_b16 a[66:67], v22 offset:12288
  v_mfma_f32_16x16x32_bf16 v[184:187], a[28:31], a[80:83], v[184:187]
  ds_read_b64_tr_b16 a[70:71], v23 offset:12288
  v_mfma_f32_16x16x32_bf16 v[188:191], a[32:35], a[80:83], v[188:191]
  buffer_load_dwordx4 v13, s[60:63], s82 offen lds
  v_mfma_f32_16x16x32_bf16 v[192:195], a[36:39], a[80:83], v[192:195]
  ds_read_b64_tr_b16 a[2:3], v25 offset:32272
  ds_read_b64_tr_b16 a[6:7], v25 offset:32288
  v_mfma_f32_16x16x32_bf16 v[196:199], a[40:43], a[80:83], v[196:199]
  s_add_u32 m0, s84, 59424
  v_mfma_f32_16x16x32_bf16 v[200:203], a[44:47], a[80:83], v[200:203]
  ds_read_b64_tr_b16 a[10:11], v25 offset:32304
  v_mfma_f32_16x16x32_bf16 v[204:207], a[48:51], a[80:83], v[204:207]
  buffer_load_dwordx4 v14, s[60:63], s82 offen lds
  v_mfma_f32_16x16x32_bf16 v[208:211], a[52:55], a[80:83], v[208:211]
  ds_read_b64_tr_b16 a[14:15], v25 offset:32320
  ds_read_b64_tr_b16 a[18:19], v25 offset:32336
  v_mfma_f32_16x16x32_bf16 v[212:215], a[28:31], a[84:87], v[212:215]
  s_add_u32 m0, s84, 60448
  v_mfma_f32_16x16x32_bf16 v[216:219], a[32:35], a[84:87], v[216:219]
  ds_read_b64_tr_b16 a[22:23], v25 offset:32352
  v_mfma_f32_16x16x32_bf16 v[220:223], a[36:39], a[84:87], v[220:223]
  buffer_load_dwordx4 v15, s[60:63], s82 offen lds
  v_mfma_f32_16x16x32_bf16 v[224:227], a[40:43], a[84:87], v[224:227]
  ds_read_b64_tr_b16 a[26:27], v25 offset:32368
  v_mfma_f32_16x16x32_bf16 v[228:231], a[44:47], a[84:87], v[228:231]
  v_mfma_f32_16x16x32_bf16 v[232:235], a[48:51], a[84:87], v[232:235]
  v_mfma_f32_16x16x32_bf16 v[236:239], a[52:55], a[84:87], v[236:239]
  s_waitcnt vmcnt(20)
  s_waitcnt lgkmcnt(0)
  s_barrier
  v_mfma_f32_16x16x32_bf16 v[128:131], a[0:3], a[56:59], v[128:131]
  ds_read_b64_tr_b16 a[72:73], v20 offset:16384
  s_mov_b32 s81, 6684672
  v_mfma_f32_16x16x32_bf16 v[132:135], a[4:7], a[56:59], v[132:135]
  ds_read_b64_tr_b16 a[76:77], v21 offset:16384
  v_mfma_f32_16x16x32_bf16 v[136:139], a[8:11], a[56:59], v[136:139]
  ds_read_b64_tr_b16 a[80:81], v22 offset:16384
  v_mfma_f32_16x16x32_bf16 v[140:143], a[12:15], a[56:59], v[140:143]
  s_add_u32 m0, s83, 123136
  v_mfma_f32_16x16x32_bf16 v[144:147], a[16:19], a[56:59], v[144:147]
  ds_read_b64_tr_b16 a[84:85], v23 offset:16384
  v_mfma_f32_16x16x32_bf16 v[148:151], a[20:23], a[56:59], v[148:151]
  ds_read_b64_tr_b16 a[28:29], v25 offset:35856
  v_mfma_f32_16x16x32_bf16 v[152:155], a[24:27], a[56:59], v[152:155]
  buffer_load_dwordx4 v10, s[44:47], s81 offen sc1 lds
  v_mfma_f32_16x16x32_bf16 v[112:115], a[88:91], a[56:59], v[112:115]
  ds_read_b64_tr_b16 a[32:33], v25 offset:35872
  ds_read_b64_tr_b16 a[36:37], v25 offset:35888
  v_mfma_f32_16x16x32_bf16 v[120:123], a[56:59], a[56:59], v[120:123]
  s_add_u32 m0, s83, 124160
  v_mfma_f32_16x16x32_bf16 v[156:159], a[0:3], a[60:63], v[156:159]
  ds_read_b64_tr_b16 a[40:41], v25 offset:35904
  v_mfma_f32_16x16x32_bf16 v[160:163], a[4:7], a[60:63], v[160:163]
  ds_read_b64_tr_b16 a[44:45], v25 offset:35920
  v_mfma_f32_16x16x32_bf16 v[164:167], a[8:11], a[60:63], v[164:167]
  buffer_load_dwordx4 v11, s[44:47], s81 offen sc1 lds
  v_mfma_f32_16x16x32_bf16 v[168:171], a[12:15], a[60:63], v[168:171]
  ds_read_b64_tr_b16 a[48:49], v25 offset:35936
  v_mfma_f32_16x16x32_bf16 v[172:175], a[16:19], a[60:63], v[172:175]
  ds_read_b64_tr_b16 a[52:53], v25 offset:35952
  v_mfma_f32_16x16x32_bf16 v[176:179], a[20:23], a[60:63], v[176:179]
  s_add_u32 m0, s84, 61472
  ds_read_b64_tr_b16 a[74:75], v20 offset:20480
  v_mfma_f32_16x16x32_bf16 v[180:183], a[24:27], a[60:63], v[180:183]
  ds_read_b64_tr_b16 a[78:79], v21 offset:20480
  v_mfma_f32_16x16x32_bf16 v[116:119], a[88:91], a[60:63], v[116:119]
  buffer_load_dwordx4 v16, s[60:63], s82 offen lds
  v_mfma_f32_16x16x32_bf16 v[124:127], a[60:63], a[60:63], v[124:127]
  ds_read_b64_tr_b16 a[82:83], v22 offset:20480
  v_mfma_f32_16x16x32_bf16 v[184:187], a[0:3], a[64:67], v[184:187]
  ds_read_b64_tr_b16 a[86:87], v23 offset:20480
  v_mfma_f32_16x16x32_bf16 v[188:191], a[4:7], a[64:67], v[188:191]
  s_add_u32 m0, s84, 62496
  v_mfma_f32_16x16x32_bf16 v[192:195], a[8:11], a[64:67], v[192:195]
  ds_read_b64_tr_b16 a[30:31], v25 offset:39440
  v_mfma_f32_16x16x32_bf16 v[196:199], a[12:15], a[64:67], v[196:199]
  ds_read_b64_tr_b16 a[34:35], v25 offset:39456
  buffer_load_dwordx4 v17, s[60:63], s82 offen lds
  v_mfma_f32_16x16x32_bf16 v[200:203], a[16:19], a[64:67], v[200:203]
  ds_read_b64_tr_b16 a[38:39], v25 offset:39472
  v_mfma_f32_16x16x32_bf16 v[204:207], a[20:23], a[64:67], v[204:207]
  ds_read_b64_tr_b16 a[42:43], v25 offset:39488
  v_mfma_f32_16x16x32_bf16 v[208:211], a[24:27], a[64:67], v[208:211]
  s_add_u32 m0, s84, 63520
  v_mfma_f32_16x16x32_bf16 v[212:215], a[0:3], a[68:71], v[212:215]
  ds_read_b64_tr_b16 a[46:47], v25 offset:39504
  v_mfma_f32_16x16x32_bf16 v[216:219], a[4:7], a[68:71], v[216:219]
  ds_read_b64_tr_b16 a[50:51], v25 offset:39520
  v_mfma_f32_16x16x32_bf16 v[220:223], a[8:11], a[68:71], v[220:223]
  buffer_load_dwordx4 v18, s[60:63], s82 offen lds
  v_mfma_f32_16x16x32_bf16 v[224:227], a[12:15], a[68:71], v[224:227]
  ds_read_b64_tr_b16 a[54:55], v25 offset:39536
  v_mfma_f32_16x16x32_bf16 v[228:231], a[16:19], a[68:71], v[228:231]
  v_mfma_f32_16x16x32_bf16 v[232:235], a[20:23], a[68:71], v[232:235]
  v_mfma_f32_16x16x32_bf16 v[236:239], a[24:27], a[68:71], v[236:239]
  s_waitcnt vmcnt(20)
  s_waitcnt lgkmcnt(0)
  s_barrier
  v_mfma_f32_16x16x32_bf16 v[128:131], a[28:31], a[72:75], v[128:131]
  ds_read_b64_tr_b16 a[56:57], v20 offset:24576
  s_mov_b32 s81, 6815744
  v_mfma_f32_16x16x32_bf16 v[132:135], a[32:35], a[72:75], v[132:135]
  ds_read_b64_tr_b16 a[60:61], v21 offset:24576
  v_mfma_f32_16x16x32_bf16 v[136:139], a[36:39], a[72:75], v[136:139]
  s_add_u32 m0, s83, 131328
  v_mfma_f32_16x16x32_bf16 v[140:143], a[40:43], a[72:75], v[140:143]
  ds_read_b64_tr_b16 a[64:65], v22 offset:24576
  v_mfma_f32_16x16x32_bf16 v[144:147], a[44:47], a[72:75], v[144:147]
  ds_read_b64_tr_b16 a[68:69], v23 offset:24576
  buffer_load_dwordx4 v10, s[44:47], s81 offen sc1 lds
  v_mfma_f32_16x16x32_bf16 v[148:151], a[48:51], a[72:75], v[148:151]
  ds_read_b64_tr_b16 a[0:1], v24 offset:0
  v_mfma_f32_16x16x32_bf16 v[152:155], a[52:55], a[72:75], v[152:155]
  ds_read_b64_tr_b16 a[4:5], v24 offset:16
  v_mfma_f32_16x16x32_bf16 v[112:115], a[88:91], a[72:75], v[112:115]
  s_add_u32 m0, s83, 132352
  v_mfma_f32_16x16x32_bf16 v[120:123], a[72:75], a[72:75], v[120:123]
  ds_read_b64_tr_b16 a[8:9], v24 offset:32
  buffer_load_dwordx4 v11, s[44:47], s81 offen sc1 lds
  v_mfma_f32_16x16x32_bf16 v[156:159], a[28:31], a[76:79], v[156:159]
  ds_read_b64_tr_b16 a[12:13], v24 offset:48
  v_mfma_f32_16x16x32_bf16 v[160:163], a[32:35], a[76:79], v[160:163]
  ds_read_b64_tr_b16 a[16:17], v24 offset:64
  v_mfma_f32_16x16x32_bf16 v[164:167], a[36:39], a[76:79], v[164:167]
  s_mov_b32 s82, 1605632
  v_mfma_f32_16x16x32_bf16 v[168:171], a[40:43], a[76:79], v[168:171]
  ds_read_b64_tr_b16 a[20:21], v24 offset:80
  s_add_u32 m0, s84, 86064
  v_mfma_f32_16x16x32_bf16 v[172:175], a[44:47], a[76:79], v[172:175]
  ds_read_b64_tr_b16 a[24:25], v24 offset:96
  v_mfma_f32_16x16x32_bf16 v[176:179], a[48:51], a[76:79], v[176:179]
  ds_read_b64_tr_b16 a[58:59], v20 offset:28672
  v_mfma_f32_16x16x32_bf16 v[180:183], a[52:55], a[76:79], v[180:183]
  buffer_load_dwordx4 v12, s[60:63], s82 offen lds
  v_mfma_f32_16x16x32_bf16 v[116:119], a[88:91], a[76:79], v[116:119]
  ds_read_b64_tr_b16 a[62:63], v21 offset:28672
  s_add_u32 m0, s84, 87088
  v_mfma_f32_16x16x32_bf16 v[124:127], a[76:79], a[76:79], v[124:127]
  ds_read_b64_tr_b16 a[66:67], v22 offset:28672
  v_mfma_f32_16x16x32_bf16 v[184:187], a[28:31], a[80:83], v[184:187]
  ds_read_b64_tr_b16 a[70:71], v23 offset:28672
  v_mfma_f32_16x16x32_bf16 v[188:191], a[32:35], a[80:83], v[188:191]
  buffer_load_dwordx4 v13, s[60:63], s82 offen lds
  v_mfma_f32_16x16x32_bf16 v[192:195], a[36:39], a[80:83], v[192:195]
  ds_read_b64_tr_b16 a[2:3], v24 offset:3584
  ds_read_b64_tr_b16 a[6:7], v24 offset:3600
  v_mfma_f32_16x16x32_bf16 v[196:199], a[40:43], a[80:83], v[196:199]
  s_add_u32 m0, s84, 88112
  v_mfma_f32_16x16x32_bf16 v[200:203], a[44:47], a[80:83], v[200:203]
  ds_read_b64_tr_b16 a[10:11], v24 offset:3616
  v_mfma_f32_16x16x32_bf16 v[204:207], a[48:51], a[80:83], v[204:207]
  buffer_load_dwordx4 v14, s[60:63], s82 offen lds
  v_mfma_f32_16x16x32_bf16 v[208:211], a[52:55], a[80:83], v[208:211]
  ds_read_b64_tr_b16 a[14:15], v24 offset:3632
  ds_read_b64_tr_b16 a[18:19], v24 offset:3648
  v_mfma_f32_16x16x32_bf16 v[212:215], a[28:31], a[84:87], v[212:215]
  s_add_u32 m0, s84, 89136
  v_mfma_f32_16x16x32_bf16 v[216:219], a[32:35], a[84:87], v[216:219]
  ds_read_b64_tr_b16 a[22:23], v24 offset:3664
  v_mfma_f32_16x16x32_bf16 v[220:223], a[36:39], a[84:87], v[220:223]
  buffer_load_dwordx4 v15, s[60:63], s82 offen lds
  v_mfma_f32_16x16x32_bf16 v[224:227], a[40:43], a[84:87], v[224:227]
  ds_read_b64_tr_b16 a[26:27], v24 offset:3680
  v_mfma_f32_16x16x32_bf16 v[228:231], a[44:47], a[84:87], v[228:231]
  v_mfma_f32_16x16x32_bf16 v[232:235], a[48:51], a[84:87], v[232:235]
  v_mfma_f32_16x16x32_bf16 v[236:239], a[52:55], a[84:87], v[236:239]
  s_waitcnt vmcnt(20)
  s_waitcnt lgkmcnt(0)
  s_barrier
  v_mfma_f32_16x16x32_bf16 v[128:131], a[0:3], a[56:59], v[128:131]
  ds_read_b64_tr_b16 a[72:73], v20 offset:32768
  s_mov_b32 s81, 6946816
  v_mfma_f32_16x16x32_bf16 v[132:135], a[4:7], a[56:59], v[132:135]
  ds_read_b64_tr_b16 a[76:77], v21 offset:32768
  v_mfma_f32_16x16x32_bf16 v[136:139], a[8:11], a[56:59], v[136:139]
  ds_read_b64_tr_b16 a[80:81], v22 offset:32768
  v_mfma_f32_16x16x32_bf16 v[140:143], a[12:15], a[56:59], v[140:143]
  s_add_u32 m0, s83, 139520
  v_mfma_f32_16x16x32_bf16 v[144:147], a[16:19], a[56:59], v[144:147]
  ds_read_b64_tr_b16 a[84:85], v23 offset:32768
  v_mfma_f32_16x16x32_bf16 v[148:151], a[20:23], a[56:59], v[148:151]
  ds_read_b64_tr_b16 a[28:29], v24 offset:7168
  v_mfma_f32_16x16x32_bf16 v[152:155], a[24:27], a[56:59], v[152:155]
  buffer_load_dwordx4 v10, s[44:47], s81 offen sc1 lds
  v_mfma_f32_16x16x32_bf16 v[112:115], a[88:91], a[56:59], v[112:115]
  ds_read_b64_tr_b16 a[32:33], v24 offset:7184
  ds_read_b64_tr_b16 a[36:37], v24 offset:7200
  v_mfma_f32_16x16x32_bf16 v[120:123], a[56:59], a[56:59], v[120:123]
  s_add_u32 m0, s83, 140544
  v_mfma_f32_16x16x32_bf16 v[156:159], a[0:3], a[60:63], v[156:159]
  ds_read_b64_tr_b16 a[40:41], v24 offset:7216
  v_mfma_f32_16x16x32_bf16 v[160:163], a[4:7], a[60:63], v[160:163]
  ds_read_b64_tr_b16 a[44:45], v24 offset:7232
  v_mfma_f32_16x16x32_bf16 v[164:167], a[8:11], a[60:63], v[164:167]
  buffer_load_dwordx4 v11, s[44:47], s81 offen sc1 lds
  v_mfma_f32_16x16x32_bf16 v[168:171], a[12:15], a[60:63], v[168:171]
  ds_read_b64_tr_b16 a[48:49], v24 offset:7248
  v_mfma_f32_16x16x32_bf16 v[172:175], a[16:19], a[60:63], v[172:175]
  ds_read_b64_tr_b16 a[52:53], v24 offset:7264
  v_mfma_f32_16x16x32_bf16 v[176:179], a[20:23], a[60:63], v[176:179]
  s_add_u32 m0, s84, 90160
  ds_read_b64_tr_b16 a[74:75], v20 offset:36864
  v_mfma_f32_16x16x32_bf16 v[180:183], a[24:27], a[60:63], v[180:183]
  ds_read_b64_tr_b16 a[78:79], v21 offset:36864
  v_mfma_f32_16x16x32_bf16 v[116:119], a[88:91], a[60:63], v[116:119]
  buffer_load_dwordx4 v16, s[60:63], s82 offen lds
  v_mfma_f32_16x16x32_bf16 v[124:127], a[60:63], a[60:63], v[124:127]
  ds_read_b64_tr_b16 a[82:83], v22 offset:36864
  v_mfma_f32_16x16x32_bf16 v[184:187], a[0:3], a[64:67], v[184:187]
  ds_read_b64_tr_b16 a[86:87], v23 offset:36864
  v_mfma_f32_16x16x32_bf16 v[188:191], a[4:7], a[64:67], v[188:191]
  s_add_u32 m0, s84, 91184
  v_mfma_f32_16x16x32_bf16 v[192:195], a[8:11], a[64:67], v[192:195]
  ds_read_b64_tr_b16 a[30:31], v24 offset:10752
  v_mfma_f32_16x16x32_bf16 v[196:199], a[12:15], a[64:67], v[196:199]
  ds_read_b64_tr_b16 a[34:35], v24 offset:10768
  buffer_load_dwordx4 v17, s[60:63], s82 offen lds
  v_mfma_f32_16x16x32_bf16 v[200:203], a[16:19], a[64:67], v[200:203]
  ds_read_b64_tr_b16 a[38:39], v24 offset:10784
  v_mfma_f32_16x16x32_bf16 v[204:207], a[20:23], a[64:67], v[204:207]
  ds_read_b64_tr_b16 a[42:43], v24 offset:10800
  v_mfma_f32_16x16x32_bf16 v[208:211], a[24:27], a[64:67], v[208:211]
  s_add_u32 m0, s84, 92208
  v_mfma_f32_16x16x32_bf16 v[212:215], a[0:3], a[68:71], v[212:215]
  ds_read_b64_tr_b16 a[46:47], v24 offset:10816
  v_mfma_f32_16x16x32_bf16 v[216:219], a[4:7], a[68:71], v[216:219]
  ds_read_b64_tr_b16 a[50:51], v24 offset:10832
  v_mfma_f32_16x16x32_bf16 v[220:223], a[8:11], a[68:71], v[220:223]
  buffer_load_dwordx4 v18, s[60:63], s82 offen lds
  v_mfma_f32_16x16x32_bf16 v[224:227], a[12:15], a[68:71], v[224:227]
  ds_read_b64_tr_b16 a[54:55], v24 offset:10848
  v_mfma_f32_16x16x32_bf16 v[228:231], a[16:19], a[68:71], v[228:231]
  v_mfma_f32_16x16x32_bf16 v[232:235], a[20:23], a[68:71], v[232:235]
  v_mfma_f32_16x16x32_bf16 v[236:239], a[24:27], a[68:71], v[236:239]
  s_waitcnt vmcnt(20)
  s_waitcnt lgkmcnt(0)
  s_barrier
  v_mfma_f32_16x16x32_bf16 v[128:131], a[28:31], a[72:75], v[128:131]
  ds_read_b64_tr_b16 a[56:57], v20 offset:0
  s_mov_b32 s81, 7077888
  v_mfma_f32_16x16x32_bf16 v[132:135], a[32:35], a[72:75], v[132:135]
  ds_read_b64_tr_b16 a[60:61], v21 offset:0
  v_mfma_f32_16x16x32_bf16 v[136:139], a[36:39], a[72:75], v[136:139]
  ds_read_b64_tr_b16 a[64:65], v22 offset:0
  v_mfma_f32_16x16x32_bf16 v[140:143], a[40:43], a[72:75], v[140:143]
  s_add_u32 m0, s83, 147712
  v_mfma_f32_16x16x32_bf16 v[144:147], a[44:47], a[72:75], v[144:147]
  ds_read_b64_tr_b16 a[68:69], v23 offset:0
  v_mfma_f32_16x16x32_bf16 v[148:151], a[48:51], a[72:75], v[148:151]
  ds_read_b64_tr_b16 a[0:1], v24 offset:28688
  buffer_load_dwordx4 v10, s[44:47], s81 offen sc1 lds
  v_mfma_f32_16x16x32_bf16 v[152:155], a[52:55], a[72:75], v[152:155]
  ds_read_b64_tr_b16 a[4:5], v24 offset:28704
  v_mfma_f32_16x16x32_bf16 v[112:115], a[88:91], a[72:75], v[112:115]
  s_add_u32 m0, s83, 148736
  v_mfma_f32_16x16x32_bf16 v[120:123], a[72:75], a[72:75], v[120:123]
  ds_read_b64_tr_b16 a[8:9], v24 offset:28720
  v_mfma_f32_16x16x32_bf16 v[156:159], a[28:31], a[76:79], v[156:159]
  ds_read_b64_tr_b16 a[12:13], v24 offset:28736
  v_mfma_f32_16x16x32_bf16 v[160:163], a[32:35], a[76:79], v[160:163]
  buffer_load_dwordx4 v11, s[44:47], s81 offen sc1 lds
  v_mfma_f32_16x16x32_bf16 v[164:167], a[36:39], a[76:79], v[164:167]
  ds_read_b64_tr_b16 a[16:17], v24 offset:28752
  ds_read_b64_tr_b16 a[20:21], v24 offset:28768
  v_mfma_f32_16x16x32_bf16 v[168:171], a[40:43], a[76:79], v[168:171]
  buffer_load_dwordx4 a[92:95], v38, s[44:47], s87 offen offset:0 sc1
  v_mfma_f32_16x16x32_bf16 v[172:175], a[44:47], a[76:79], v[172:175]
  ds_read_b64_tr_b16 a[24:25], v24 offset:28784
  v_mfma_f32_16x16x32_bf16 v[176:179], a[48:51], a[76:79], v[176:179]
  ds_read_b64_tr_b16 a[58:59], v20 offset:4096
  v_mfma_f32_16x16x32_bf16 v[180:183], a[52:55], a[76:79], v[180:183]
  buffer_load_dwordx4 a[96:99], v38, s[44:47], s87 offen offset:1024 sc1
  v_mfma_f32_16x16x32_bf16 v[116:119], a[88:91], a[76:79], v[116:119]
  ds_read_b64_tr_b16 a[62:63], v21 offset:4096
  v_mfma_f32_16x16x32_bf16 v[124:127], a[76:79], a[76:79], v[124:127]
  ds_read_b64_tr_b16 a[66:67], v22 offset:4096
  buffer_load_dwordx4 a[100:103], v38, s[44:47], s87 offen offset:2048 sc1
  v_mfma_f32_16x16x32_bf16 v[184:187], a[28:31], a[80:83], v[184:187]
  ds_read_b64_tr_b16 a[70:71], v23 offset:4096
  v_mfma_f32_16x16x32_bf16 v[188:191], a[32:35], a[80:83], v[188:191]
  ds_read_b64_tr_b16 a[2:3], v24 offset:32272
  v_mfma_f32_16x16x32_bf16 v[192:195], a[36:39], a[80:83], v[192:195]
  buffer_load_dwordx4 a[104:107], v38, s[44:47], s87 offen offset:3072 sc1
  v_mfma_f32_16x16x32_bf16 v[196:199], a[40:43], a[80:83], v[196:199]
  ds_read_b64_tr_b16 a[6:7], v24 offset:32288
  v_mfma_f32_16x16x32_bf16 v[200:203], a[44:47], a[80:83], v[200:203]
  s_add_u32 s87, s87, 32768
  v_mfma_f32_16x16x32_bf16 v[204:207], a[48:51], a[80:83], v[204:207]
  ds_read_b64_tr_b16 a[10:11], v24 offset:32304
  ds_read_b64_tr_b16 a[14:15], v24 offset:32320
  v_mfma_f32_16x16x32_bf16 v[208:211], a[52:55], a[80:83], v[208:211]
  buffer_load_dwordx4 a[108:111], v38, s[44:47], s87 offen offset:0 sc1
  v_mfma_f32_16x16x32_bf16 v[212:215], a[28:31], a[84:87], v[212:215]
  ds_read_b64_tr_b16 a[18:19], v24 offset:32336
  v_mfma_f32_16x16x32_bf16 v[216:219], a[32:35], a[84:87], v[216:219]
  ds_read_b64_tr_b16 a[22:23], v24 offset:32352
  v_mfma_f32_16x16x32_bf16 v[220:223], a[36:39], a[84:87], v[220:223]
  buffer_load_dwordx4 a[112:115], v38, s[44:47], s87 offen offset:1024 sc1
  v_mfma_f32_16x16x32_bf16 v[224:227], a[40:43], a[84:87], v[224:227]
  ds_read_b64_tr_b16 a[26:27], v24 offset:32368
  v_mfma_f32_16x16x32_bf16 v[228:231], a[44:47], a[84:87], v[228:231]
  v_mfma_f32_16x16x32_bf16 v[232:235], a[48:51], a[84:87], v[232:235]
  v_mfma_f32_16x16x32_bf16 v[236:239], a[52:55], a[84:87], v[236:239]
  s_waitcnt vmcnt(22)
  s_waitcnt lgkmcnt(0)
  s_barrier
  v_mfma_f32_16x16x32_bf16 v[128:131], a[0:3], a[56:59], v[128:131]
  ds_read_b64_tr_b16 a[72:73], v20 offset:8192
  s_mov_b32 s81, 7208960
  v_mfma_f32_16x16x32_bf16 v[132:135], a[4:7], a[56:59], v[132:135]
  ds_read_b64_tr_b16 a[76:77], v21 offset:8192
  v_mfma_f32_16x16x32_bf16 v[136:139], a[8:11], a[56:59], v[136:139]
  ds_read_b64_tr_b16 a[80:81], v22 offset:8192
  v_mfma_f32_16x16x32_bf16 v[140:143], a[12:15], a[56:59], v[140:143]
  s_add_u32 m0, s83, 114944
  v_mfma_f32_16x16x32_bf16 v[144:147], a[16:19], a[56:59], v[144:147]
  ds_read_b64_tr_b16 a[84:85], v23 offset:8192
  v_mfma_f32_16x16x32_bf16 v[148:151], a[20:23], a[56:59], v[148:151]
  ds_read_b64_tr_b16 a[28:29], v24 offset:35856
  buffer_load_dwordx4 v10, s[44:47], s81 offen sc1 lds
  v_mfma_f32_16x16x32_bf16 v[152:155], a[24:27], a[56:59], v[152:155]
  ds_read_b64_tr_b16 a[32:33], v24 offset:35872
  v_mfma_f32_16x16x32_bf16 v[112:115], a[88:91], a[56:59], v[112:115]
  s_add_u32 m0, s83, 115968
  v_mfma_f32_16x16x32_bf16 v[120:123], a[56:59], a[56:59], v[120:123]
  ds_read_b64_tr_b16 a[36:37], v24 offset:35888
  v_mfma_f32_16x16x32_bf16 v[156:159], a[0:3], a[60:63], v[156:159]
  ds_read_b64_tr_b16 a[40:41], v24 offset:35904
  v_mfma_f32_16x16x32_bf16 v[160:163], a[4:7], a[60:63], v[160:163]
  buffer_load_dwordx4 v11, s[44:47], s81 offen sc1 lds
  v_mfma_f32_16x16x32_bf16 v[164:167], a[8:11], a[60:63], v[164:167]
  ds_read_b64_tr_b16 a[44:45], v24 offset:35920
  ds_read_b64_tr_b16 a[48:49], v24 offset:35936
  v_mfma_f32_16x16x32_bf16 v[168:171], a[12:15], a[60:63], v[168:171]
  buffer_load_dwordx4 a[116:119], v38, s[44:47], s87 offen offset:2048 sc1
  v_mfma_f32_16x16x32_bf16 v[172:175], a[16:19], a[60:63], v[172:175]
  ds_read_b64_tr_b16 a[52:53], v24 offset:35952
  v_mfma_f32_16x16x32_bf16 v[176:179], a[20:23], a[60:63], v[176:179]
  ds_read_b64_tr_b16 a[74:75], v20 offset:12288
  v_mfma_f32_16x16x32_bf16 v[180:183], a[24:27], a[60:63], v[180:183]
  buffer_load_dwordx4 a[120:123], v38, s[44:47], s87 offen offset:3072 sc1
  v_mfma_f32_16x16x32_bf16 v[116:119], a[88:91], a[60:63], v[116:119]
  ds_read_b64_tr_b16 a[78:79], v21 offset:12288
  v_mfma_f32_16x16x32_bf16 v[124:127], a[60:63], a[60:63], v[124:127]
  ds_read_b64_tr_b16 a[82:83], v22 offset:12288
  s_add_u32 s87, s87, 32768
  v_mfma_f32_16x16x32_bf16 v[184:187], a[0:3], a[64:67], v[184:187]
  ds_read_b64_tr_b16 a[86:87], v23 offset:12288
  v_mfma_f32_16x16x32_bf16 v[188:191], a[4:7], a[64:67], v[188:191]
  ds_read_b64_tr_b16 a[30:31], v24 offset:39440
  v_mfma_f32_16x16x32_bf16 v[192:195], a[8:11], a[64:67], v[192:195]
  buffer_load_dwordx4 a[124:127], v38, s[44:47], s87 offen offset:0 sc1
  v_mfma_f32_16x16x32_bf16 v[196:199], a[12:15], a[64:67], v[196:199]
  ds_read_b64_tr_b16 a[34:35], v24 offset:39456
  v_mfma_f32_16x16x32_bf16 v[200:203], a[16:19], a[64:67], v[200:203]
  buffer_load_dwordx4 a[128:131], v38, s[44:47], s87 offen offset:1024 sc1
  v_mfma_f32_16x16x32_bf16 v[204:207], a[20:23], a[64:67], v[204:207]
  ds_read_b64_tr_b16 a[38:39], v24 offset:39472
  ds_read_b64_tr_b16 a[42:43], v24 offset:39488
  v_mfma_f32_16x16x32_bf16 v[208:211], a[24:27], a[64:67], v[208:211]
  buffer_load_dwordx4 a[132:135], v38, s[44:47], s87 offen offset:2048 sc1
  v_mfma_f32_16x16x32_bf16 v[212:215], a[0:3], a[68:71], v[212:215]
  ds_read_b64_tr_b16 a[46:47], v24 offset:39504
  v_mfma_f32_16x16x32_bf16 v[216:219], a[4:7], a[68:71], v[216:219]
  ds_read_b64_tr_b16 a[50:51], v24 offset:39520
  v_mfma_f32_16x16x32_bf16 v[220:223], a[8:11], a[68:71], v[220:223]
  buffer_load_dwordx4 a[136:139], v38, s[44:47], s87 offen offset:3072 sc1
  v_mfma_f32_16x16x32_bf16 v[224:227], a[12:15], a[68:71], v[224:227]
  ds_read_b64_tr_b16 a[54:55], v24 offset:39536
  v_mfma_f32_16x16x32_bf16 v[228:231], a[16:19], a[68:71], v[228:231]
  v_mfma_f32_16x16x32_bf16 v[232:235], a[20:23], a[68:71], v[232:235]
  v_mfma_f32_16x16x32_bf16 v[236:239], a[24:27], a[68:71], v[236:239]
  s_waitcnt vmcnt(25)
  s_waitcnt lgkmcnt(0)
  s_barrier
  v_mfma_f32_16x16x32_bf16 v[128:131], a[28:31], a[72:75], v[128:131]
  ds_read_b64_tr_b16 a[56:57], v20 offset:16384
  s_add_u32 s87, s87, 32768
  v_mfma_f32_16x16x32_bf16 v[132:135], a[32:35], a[72:75], v[132:135]
  ds_read_b64_tr_b16 a[60:61], v21 offset:16384
  v_mfma_f32_16x16x32_bf16 v[136:139], a[36:39], a[72:75], v[136:139]
  ds_read_b64_tr_b16 a[64:65], v22 offset:16384
  v_mfma_f32_16x16x32_bf16 v[140:143], a[40:43], a[72:75], v[140:143]
  ds_read_b64_tr_b16 a[68:69], v23 offset:16384
  v_mfma_f32_16x16x32_bf16 v[144:147], a[44:47], a[72:75], v[144:147]
  buffer_load_dwordx4 a[140:143], v38, s[44:47], s87 offen offset:0 sc1
  v_mfma_f32_16x16x32_bf16 v[148:151], a[48:51], a[72:75], v[148:151]
  ds_read_b64_tr_b16 a[0:1], v25 offset:0
  v_mfma_f32_16x16x32_bf16 v[152:155], a[52:55], a[72:75], v[152:155]
  ds_read_b64_tr_b16 a[4:5], v25 offset:16
  v_mfma_f32_16x16x32_bf16 v[112:115], a[88:91], a[72:75], v[112:115]
  ds_read_b64_tr_b16 a[8:9], v25 offset:32
  v_mfma_f32_16x16x32_bf16 v[120:123], a[72:75], a[72:75], v[120:123]
  buffer_load_dwordx4 a[144:147], v38, s[44:47], s87 offen offset:1024 sc1
  v_mfma_f32_16x16x32_bf16 v[156:159], a[28:31], a[76:79], v[156:159]
  ds_read_b64_tr_b16 a[12:13], v25 offset:48
  v_mfma_f32_16x16x32_bf16 v[160:163], a[32:35], a[76:79], v[160:163]
  ds_read_b64_tr_b16 a[16:17], v25 offset:64
  v_mfma_f32_16x16x32_bf16 v[164:167], a[36:39], a[76:79], v[164:167]
  ds_read_b64_tr_b16 a[20:21], v25 offset:80
  v_mfma_f32_16x16x32_bf16 v[168:171], a[40:43], a[76:79], v[168:171]
  buffer_load_dwordx4 a[148:151], v38, s[44:47], s87 offen offset:2048 sc1
  v_mfma_f32_16x16x32_bf16 v[172:175], a[44:47], a[76:79], v[172:175]
  ds_read_b64_tr_b16 a[24:25], v25 offset:96
  v_mfma_f32_16x16x32_bf16 v[176:179], a[48:51], a[76:79], v[176:179]
  ds_read_b64_tr_b16 a[58:59], v20 offset:20480
  v_mfma_f32_16x16x32_bf16 v[180:183], a[52:55], a[76:79], v[180:183]
  buffer_load_dwordx4 a[152:155], v38, s[44:47], s87 offen offset:3072 sc1
  v_mfma_f32_16x16x32_bf16 v[116:119], a[88:91], a[76:79], v[116:119]
  ds_read_b64_tr_b16 a[62:63], v21 offset:20480
  v_mfma_f32_16x16x32_bf16 v[124:127], a[76:79], a[76:79], v[124:127]
  ds_read_b64_tr_b16 a[66:67], v22 offset:20480
  v_mfma_f32_16x16x32_bf16 v[184:187], a[28:31], a[80:83], v[184:187]
  ds_read_b64_tr_b16 a[70:71], v23 offset:20480
  v_mfma_f32_16x16x32_bf16 v[188:191], a[32:35], a[80:83], v[188:191]
  s_add_u32 s87, s87, 32768
  v_mfma_f32_16x16x32_bf16 v[192:195], a[36:39], a[80:83], v[192:195]
  ds_read_b64_tr_b16 a[2:3], v25 offset:3584
  v_mfma_f32_16x16x32_bf16 v[196:199], a[40:43], a[80:83], v[196:199]
  ds_read_b64_tr_b16 a[6:7], v25 offset:3600
  v_mfma_f32_16x16x32_bf16 v[200:203], a[44:47], a[80:83], v[200:203]
  ds_read_b64_tr_b16 a[10:11], v25 offset:3616
  v_mfma_f32_16x16x32_bf16 v[204:207], a[48:51], a[80:83], v[204:207]
  buffer_load_dwordx4 a[156:159], v38, s[44:47], s87 offen offset:0 sc1
  v_mfma_f32_16x16x32_bf16 v[208:211], a[52:55], a[80:83], v[208:211]
  ds_read_b64_tr_b16 a[14:15], v25 offset:3632
  v_mfma_f32_16x16x32_bf16 v[212:215], a[28:31], a[84:87], v[212:215]
  ds_read_b64_tr_b16 a[18:19], v25 offset:3648
  v_mfma_f32_16x16x32_bf16 v[216:219], a[32:35], a[84:87], v[216:219]
  ds_read_b64_tr_b16 a[22:23], v25 offset:3664
  v_mfma_f32_16x16x32_bf16 v[220:223], a[36:39], a[84:87], v[220:223]
  buffer_load_dwordx4 a[160:163], v38, s[44:47], s87 offen offset:1024 sc1
  v_mfma_f32_16x16x32_bf16 v[224:227], a[40:43], a[84:87], v[224:227]
  ds_read_b64_tr_b16 a[26:27], v25 offset:3680
  v_mfma_f32_16x16x32_bf16 v[228:231], a[44:47], a[84:87], v[228:231]
  v_mfma_f32_16x16x32_bf16 v[232:235], a[48:51], a[84:87], v[232:235]
  v_mfma_f32_16x16x32_bf16 v[236:239], a[52:55], a[84:87], v[236:239]
  s_waitcnt vmcnt(25)
  s_waitcnt lgkmcnt(0)
  s_barrier
  v_mfma_f32_16x16x32_bf16 v[128:131], a[0:3], a[56:59], v[128:131]
  ds_read_b64_tr_b16 a[72:73], v20 offset:24576
  v_mfma_f32_16x16x32_bf16 v[132:135], a[4:7], a[56:59], v[132:135]
  ds_read_b64_tr_b16 a[76:77], v21 offset:24576
  v_mfma_f32_16x16x32_bf16 v[136:139], a[8:11], a[56:59], v[136:139]
  buffer_load_dwordx4 a[164:167], v38, s[44:47], s87 offen offset:2048 sc1
  v_mfma_f32_16x16x32_bf16 v[140:143], a[12:15], a[56:59], v[140:143]
  ds_read_b64_tr_b16 a[80:81], v22 offset:24576
  v_mfma_f32_16x16x32_bf16 v[144:147], a[16:19], a[56:59], v[144:147]
  ds_read_b64_tr_b16 a[84:85], v23 offset:24576
  v_mfma_f32_16x16x32_bf16 v[148:151], a[20:23], a[56:59], v[148:151]
  ds_read_b64_tr_b16 a[28:29], v25 offset:7168
  v_mfma_f32_16x16x32_bf16 v[152:155], a[24:27], a[56:59], v[152:155]
  buffer_load_dwordx4 a[168:171], v38, s[44:47], s87 offen offset:3072 sc1
  v_mfma_f32_16x16x32_bf16 v[112:115], a[88:91], a[56:59], v[112:115]
  ds_read_b64_tr_b16 a[32:33], v25 offset:7184
  v_mfma_f32_16x16x32_bf16 v[120:123], a[56:59], a[56:59], v[120:123]
  ds_read_b64_tr_b16 a[36:37], v25 offset:7200
  v_mfma_f32_16x16x32_bf16 v[156:159], a[0:3], a[60:63], v[156:159]
  ds_read_b64_tr_b16 a[40:41], v25 offset:7216
  v_mfma_f32_16x16x32_bf16 v[160:163], a[4:7], a[60:63], v[160:163]
  s_add_u32 s87, s87, 32768
  v_mfma_f32_16x16x32_bf16 v[164:167], a[8:11], a[60:63], v[164:167]
  ds_read_b64_tr_b16 a[44:45], v25 offset:7232
  v_mfma_f32_16x16x32_bf16 v[168:171], a[12:15], a[60:63], v[168:171]
  ds_read_b64_tr_b16 a[48:49], v25 offset:7248
  v_mfma_f32_16x16x32_bf16 v[172:175], a[16:19], a[60:63], v[172:175]
  ds_read_b64_tr_b16 a[52:53], v25 offset:7264
  v_mfma_f32_16x16x32_bf16 v[176:179], a[20:23], a[60:63], v[176:179]
  buffer_load_dwordx4 a[172:175], v38, s[44:47], s87 offen offset:0 sc1
  v_mfma_f32_16x16x32_bf16 v[180:183], a[24:27], a[60:63], v[180:183]
  ds_read_b64_tr_b16 a[74:75], v20 offset:28672
  v_mfma_f32_16x16x32_bf16 v[116:119], a[88:91], a[60:63], v[116:119]
  ds_read_b64_tr_b16 a[78:79], v21 offset:28672
  v_mfma_f32_16x16x32_bf16 v[124:127], a[60:63], a[60:63], v[124:127]
  ds_read_b64_tr_b16 a[82:83], v22 offset:28672
  v_mfma_f32_16x16x32_bf16 v[184:187], a[0:3], a[64:67], v[184:187]
  buffer_load_dwordx4 a[176:179], v38, s[44:47], s87 offen offset:1024 sc1
  v_mfma_f32_16x16x32_bf16 v[188:191], a[4:7], a[64:67], v[188:191]
  ds_read_b64_tr_b16 a[86:87], v23 offset:28672
  v_mfma_f32_16x16x32_bf16 v[192:195], a[8:11], a[64:67], v[192:195]
  ds_read_b64_tr_b16 a[30:31], v25 offset:10752
  v_mfma_f32_16x16x32_bf16 v[196:199], a[12:15], a[64:67], v[196:199]
  ds_read_b64_tr_b16 a[34:35], v25 offset:10768
  v_mfma_f32_16x16x32_bf16 v[200:203], a[16:19], a[64:67], v[200:203]
  buffer_load_dwordx4 a[180:183], v38, s[44:47], s87 offen offset:2048 sc1
  v_mfma_f32_16x16x32_bf16 v[204:207], a[20:23], a[64:67], v[204:207]
  ds_read_b64_tr_b16 a[38:39], v25 offset:10784
  v_mfma_f32_16x16x32_bf16 v[208:211], a[24:27], a[64:67], v[208:211]
  ds_read_b64_tr_b16 a[42:43], v25 offset:10800
  v_mfma_f32_16x16x32_bf16 v[212:215], a[0:3], a[68:71], v[212:215]
  ds_read_b64_tr_b16 a[46:47], v25 offset:10816
  v_mfma_f32_16x16x32_bf16 v[216:219], a[4:7], a[68:71], v[216:219]
  buffer_load_dwordx4 a[184:187], v38, s[44:47], s87 offen offset:3072 sc1
  v_mfma_f32_16x16x32_bf16 v[220:223], a[8:11], a[68:71], v[220:223]
  ds_read_b64_tr_b16 a[50:51], v25 offset:10832
  v_mfma_f32_16x16x32_bf16 v[224:227], a[12:15], a[68:71], v[224:227]
  ds_read_b64_tr_b16 a[54:55], v25 offset:10848
  v_mfma_f32_16x16x32_bf16 v[228:231], a[16:19], a[68:71], v[228:231]
  v_mfma_f32_16x16x32_bf16 v[232:235], a[20:23], a[68:71], v[232:235]
  v_mfma_f32_16x16x32_bf16 v[236:239], a[24:27], a[68:71], v[236:239]
  s_waitcnt vmcnt(26)
  s_waitcnt lgkmcnt(0)
  s_barrier
  v_mfma_f32_16x16x32_bf16 v[128:131], a[28:31], a[72:75], v[128:131]
  ds_read_b64_tr_b16 a[56:57], v20 offset:32768
  s_add_u32 s87, s87, 32768
  v_mfma_f32_16x16x32_bf16 v[132:135], a[32:35], a[72:75], v[132:135]
  ds_read_b64_tr_b16 a[60:61], v21 offset:32768
  v_mfma_f32_16x16x32_bf16 v[136:139], a[36:39], a[72:75], v[136:139]
  ds_read_b64_tr_b16 a[64:65], v22 offset:32768
  v_mfma_f32_16x16x32_bf16 v[140:143], a[40:43], a[72:75], v[140:143]
  ds_read_b64_tr_b16 a[68:69], v23 offset:32768
  v_mfma_f32_16x16x32_bf16 v[144:147], a[44:47], a[72:75], v[144:147]
  buffer_load_dwordx4 a[188:191], v38, s[44:47], s87 offen offset:0 sc1
  v_mfma_f32_16x16x32_bf16 v[148:151], a[48:51], a[72:75], v[148:151]
  ds_read_b64_tr_b16 a[0:1], v25 offset:28688
  v_mfma_f32_16x16x32_bf16 v[152:155], a[52:55], a[72:75], v[152:155]
  ds_read_b64_tr_b16 a[4:5], v25 offset:28704
  v_mfma_f32_16x16x32_bf16 v[112:115], a[88:91], a[72:75], v[112:115]
  ds_read_b64_tr_b16 a[8:9], v25 offset:28720
  v_mfma_f32_16x16x32_bf16 v[120:123], a[72:75], a[72:75], v[120:123]
  buffer_load_dwordx4 a[192:195], v38, s[44:47], s87 offen offset:1024 sc1
  v_mfma_f32_16x16x32_bf16 v[156:159], a[28:31], a[76:79], v[156:159]
  ds_read_b64_tr_b16 a[12:13], v25 offset:28736
  v_mfma_f32_16x16x32_bf16 v[160:163], a[32:35], a[76:79], v[160:163]
  ds_read_b64_tr_b16 a[16:17], v25 offset:28752
  v_mfma_f32_16x16x32_bf16 v[164:167], a[36:39], a[76:79], v[164:167]
  ds_read_b64_tr_b16 a[20:21], v25 offset:28768
  v_mfma_f32_16x16x32_bf16 v[168:171], a[40:43], a[76:79], v[168:171]
  buffer_load_dwordx4 a[196:199], v38, s[44:47], s87 offen offset:2048 sc1
  v_mfma_f32_16x16x32_bf16 v[172:175], a[44:47], a[76:79], v[172:175]
  ds_read_b64_tr_b16 a[24:25], v25 offset:28784
  v_mfma_f32_16x16x32_bf16 v[176:179], a[48:51], a[76:79], v[176:179]
  ds_read_b64_tr_b16 a[58:59], v20 offset:36864
  v_mfma_f32_16x16x32_bf16 v[180:183], a[52:55], a[76:79], v[180:183]
  buffer_load_dwordx4 a[200:203], v38, s[44:47], s87 offen offset:3072 sc1
  v_mfma_f32_16x16x32_bf16 v[116:119], a[88:91], a[76:79], v[116:119]
  ds_read_b64_tr_b16 a[62:63], v21 offset:36864
  v_mfma_f32_16x16x32_bf16 v[124:127], a[76:79], a[76:79], v[124:127]
  ds_read_b64_tr_b16 a[66:67], v22 offset:36864
  v_mfma_f32_16x16x32_bf16 v[184:187], a[28:31], a[80:83], v[184:187]
  ds_read_b64_tr_b16 a[70:71], v23 offset:36864
  v_mfma_f32_16x16x32_bf16 v[188:191], a[32:35], a[80:83], v[188:191]
  s_add_u32 s87, s87, 32768
  v_mfma_f32_16x16x32_bf16 v[192:195], a[36:39], a[80:83], v[192:195]
  ds_read_b64_tr_b16 a[2:3], v25 offset:32272
  v_mfma_f32_16x16x32_bf16 v[196:199], a[40:43], a[80:83], v[196:199]
  ds_read_b64_tr_b16 a[6:7], v25 offset:32288
  v_mfma_f32_16x16x32_bf16 v[200:203], a[44:47], a[80:83], v[200:203]
  ds_read_b64_tr_b16 a[10:11], v25 offset:32304
  v_mfma_f32_16x16x32_bf16 v[204:207], a[48:51], a[80:83], v[204:207]
  buffer_load_dwordx4 a[204:207], v38, s[44:47], s87 offen offset:0 sc1
  v_mfma_f32_16x16x32_bf16 v[208:211], a[52:55], a[80:83], v[208:211]
  ds_read_b64_tr_b16 a[14:15], v25 offset:32320
  v_mfma_f32_16x16x32_bf16 v[212:215], a[28:31], a[84:87], v[212:215]
  ds_read_b64_tr_b16 a[18:19], v25 offset:32336
  v_mfma_f32_16x16x32_bf16 v[216:219], a[32:35], a[84:87], v[216:219]
  ds_read_b64_tr_b16 a[22:23], v25 offset:32352
  v_mfma_f32_16x16x32_bf16 v[220:223], a[36:39], a[84:87], v[220:223]
  buffer_load_dwordx4 a[208:211], v38, s[44:47], s87 offen offset:1024 sc1
  v_mfma_f32_16x16x32_bf16 v[224:227], a[40:43], a[84:87], v[224:227]
  ds_read_b64_tr_b16 a[26:27], v25 offset:32368
  v_mfma_f32_16x16x32_bf16 v[228:231], a[44:47], a[84:87], v[228:231]
  v_mfma_f32_16x16x32_bf16 v[232:235], a[48:51], a[84:87], v[232:235]
  v_mfma_f32_16x16x32_bf16 v[236:239], a[52:55], a[84:87], v[236:239]
  s_waitcnt vmcnt(24)
  s_waitcnt lgkmcnt(0)
  s_barrier
  v_mfma_f32_16x16x32_bf16 v[128:131], a[0:3], a[56:59], v[128:131]
  ds_read_b64_tr_b16 a[72:73], v20 offset:0
  v_mfma_f32_16x16x32_bf16 v[132:135], a[4:7], a[56:59], v[132:135]
  ds_read_b64_tr_b16 a[76:77], v21 offset:0
  v_mfma_f32_16x16x32_bf16 v[136:139], a[8:11], a[56:59], v[136:139]
  buffer_load_dwordx4 a[212:215], v38, s[44:47], s87 offen offset:2048 sc1
  v_mfma_f32_16x16x32_bf16 v[140:143], a[12:15], a[56:59], v[140:143]
  ds_read_b64_tr_b16 a[80:81], v22 offset:0
  v_mfma_f32_16x16x32_bf16 v[144:147], a[16:19], a[56:59], v[144:147]
  ds_read_b64_tr_b16 a[84:85], v23 offset:0
  v_mfma_f32_16x16x32_bf16 v[148:151], a[20:23], a[56:59], v[148:151]
  ds_read_b64_tr_b16 a[28:29], v25 offset:35856
  v_mfma_f32_16x16x32_bf16 v[152:155], a[24:27], a[56:59], v[152:155]
  buffer_load_dwordx4 a[216:219], v38, s[44:47], s87 offen offset:3072 sc1
  v_mfma_f32_16x16x32_bf16 v[112:115], a[88:91], a[56:59], v[112:115]
  ds_read_b64_tr_b16 a[32:33], v25 offset:35872
  v_mfma_f32_16x16x32_bf16 v[120:123], a[56:59], a[56:59], v[120:123]
  ds_read_b64_tr_b16 a[36:37], v25 offset:35888
  v_mfma_f32_16x16x32_bf16 v[156:159], a[0:3], a[60:63], v[156:159]
  ds_read_b64_tr_b16 a[40:41], v25 offset:35904
  v_mfma_f32_16x16x32_bf16 v[160:163], a[4:7], a[60:63], v[160:163]
  s_add_u32 s87, s87, 32768
  v_mfma_f32_16x16x32_bf16 v[164:167], a[8:11], a[60:63], v[164:167]
  ds_read_b64_tr_b16 a[44:45], v25 offset:35920
  v_mfma_f32_16x16x32_bf16 v[168:171], a[12:15], a[60:63], v[168:171]
  ds_read_b64_tr_b16 a[48:49], v25 offset:35936
  v_mfma_f32_16x16x32_bf16 v[172:175], a[16:19], a[60:63], v[172:175]
  ds_read_b64_tr_b16 a[52:53], v25 offset:35952
  v_mfma_f32_16x16x32_bf16 v[176:179], a[20:23], a[60:63], v[176:179]
  buffer_load_dwordx4 a[220:223], v38, s[44:47], s87 offen offset:0 sc1
  v_mfma_f32_16x16x32_bf16 v[180:183], a[24:27], a[60:63], v[180:183]
  ds_read_b64_tr_b16 a[74:75], v20 offset:4096
  v_mfma_f32_16x16x32_bf16 v[116:119], a[88:91], a[60:63], v[116:119]
  ds_read_b64_tr_b16 a[78:79], v21 offset:4096
  v_mfma_f32_16x16x32_bf16 v[124:127], a[60:63], a[60:63], v[124:127]
  ds_read_b64_tr_b16 a[82:83], v22 offset:4096
  v_mfma_f32_16x16x32_bf16 v[184:187], a[0:3], a[64:67], v[184:187]
  buffer_load_dwordx4 a[224:227], v38, s[44:47], s87 offen offset:1024 sc1
  v_mfma_f32_16x16x32_bf16 v[188:191], a[4:7], a[64:67], v[188:191]
  ds_read_b64_tr_b16 a[86:87], v23 offset:4096
  v_mfma_f32_16x16x32_bf16 v[192:195], a[8:11], a[64:67], v[192:195]
  ds_read_b64_tr_b16 a[30:31], v25 offset:39440
  v_mfma_f32_16x16x32_bf16 v[196:199], a[12:15], a[64:67], v[196:199]
  ds_read_b64_tr_b16 a[34:35], v25 offset:39456
  v_mfma_f32_16x16x32_bf16 v[200:203], a[16:19], a[64:67], v[200:203]
  buffer_load_dwordx4 a[228:231], v38, s[44:47], s87 offen offset:2048 sc1
  v_mfma_f32_16x16x32_bf16 v[204:207], a[20:23], a[64:67], v[204:207]
  ds_read_b64_tr_b16 a[38:39], v25 offset:39472
  v_mfma_f32_16x16x32_bf16 v[208:211], a[24:27], a[64:67], v[208:211]
  ds_read_b64_tr_b16 a[42:43], v25 offset:39488
  v_mfma_f32_16x16x32_bf16 v[212:215], a[0:3], a[68:71], v[212:215]
  ds_read_b64_tr_b16 a[46:47], v25 offset:39504
  v_mfma_f32_16x16x32_bf16 v[216:219], a[4:7], a[68:71], v[216:219]
  buffer_load_dwordx4 a[232:235], v38, s[44:47], s87 offen offset:3072 sc1
  v_mfma_f32_16x16x32_bf16 v[220:223], a[8:11], a[68:71], v[220:223]
  ds_read_b64_tr_b16 a[50:51], v25 offset:39520
  v_mfma_f32_16x16x32_bf16 v[224:227], a[12:15], a[68:71], v[224:227]
  ds_read_b64_tr_b16 a[54:55], v25 offset:39536
  v_mfma_f32_16x16x32_bf16 v[228:231], a[16:19], a[68:71], v[228:231]
  v_mfma_f32_16x16x32_bf16 v[232:235], a[20:23], a[68:71], v[232:235]
  v_mfma_f32_16x16x32_bf16 v[236:239], a[24:27], a[68:71], v[236:239]
  s_waitcnt lgkmcnt(0)
  s_barrier
  v_mfma_f32_16x16x32_bf16 v[112:115], a[88:91], a[72:75], v[112:115]
  v_mfma_f32_16x16x32_bf16 v[120:123], a[72:75], a[72:75], v[120:123]
  s_add_u32 s87, s87, 32768
  buffer_load_dwordx4 a[236:239], v38, s[44:47], s87 offen offset:0 sc1
  v_mfma_f32_16x16x32_bf16 v[116:119], a[88:91], a[76:79], v[116:119]
  buffer_load_dwordx4 a[240:243], v38, s[44:47], s87 offen offset:1024 sc1
  buffer_load_dwordx4 a[244:247], v38, s[44:47], s87 offen offset:2048 sc1
  v_mfma_f32_16x16x32_bf16 v[124:127], a[76:79], a[76:79], v[124:127]
  buffer_load_dwordx4 a[248:251], v38, s[44:47], s87 offen offset:3072 sc1
  s_add_u32 s87, s87, 32768
  v_mfma_f32_16x16x32_bf16 v[128:131], a[28:31], a[72:75], v[128:131]
  buffer_load_dwordx4 a[252:255], v38, s[44:47], s87 offen offset:0 sc1
  v_mfma_f32_16x16x32_bf16 v[132:135], a[32:35], a[72:75], v[132:135]
  v_and_b32 v2, 15, v255
  v_and_b32 v3, 3, v2
  v_mfma_f32_16x16x32_bf16 v[136:139], a[36:39], a[72:75], v[136:139]
  v_cmp_eq_u32 s[64:65], 1, v3
  v_cmp_eq_u32 s[66:67], 2, v3
  v_mfma_f32_16x16x32_bf16 v[140:143], a[40:43], a[72:75], v[140:143]
  v_cmp_eq_u32 s[72:73], 3, v3
  v_lshrrev_b32 v3, 2, v2
  v_mfma_f32_16x16x32_bf16 v[144:147], a[44:47], a[72:75], v[144:147]
  v_lshrrev_b32 v6, 4, v255
  v_mfma_f32_16x16x32_bf16 v[148:151], a[48:51], a[72:75], v[148:151]
  v_cmp_eq_u32 s[74:75], v3, v6
  s_lshl_b32 s3, s79, 6
  v_mfma_f32_16x16x32_bf16 v[152:155], a[52:55], a[72:75], v[152:155]
  s_lshl_b32 s98, s80, 5
  s_add_u32 s3, s3, s98
  v_mfma_f32_16x16x32_bf16 v[156:159], a[28:31], a[76:79], v[156:159]
  v_add_u32 v2, s3, v2
  v_lshlrev_b32 v2, 3, v2
  v_mfma_f32_16x16x32_bf16 v[160:163], a[32:35], a[76:79], v[160:163]
  v_add_u32 v2, 157184, v2
  v_mfma_f32_16x16x32_bf16 v[164:167], a[36:39], a[76:79], v[164:167]
  v_mov_b32 v7, 158208
  v_cndmask_b32 v7, v7, v2, s[74:75]
  v_mfma_f32_16x16x32_bf16 v[168:171], a[40:43], a[76:79], v[168:171]
  v_bfe_u32 v8, v255, 4, 1
  v_lshlrev_b32 v8, 4, v8
  v_mfma_f32_16x16x32_bf16 v[172:175], a[44:47], a[76:79], v[172:175]
  s_mul_i32 s98, s80, 224
  v_mfma_f32_16x16x32_bf16 v[176:179], a[48:51], a[76:79], v[176:179]
  s_add_u32 s98, s98, 159232
  v_add_u32 v8, s98, v8
  v_mfma_f32_16x16x32_bf16 v[180:183], a[52:55], a[76:79], v[180:183]
  v_cndmask_b32 v4, v120, v121, s[64:65]
  v_cndmask_b32 v4, v4, v122, s[66:67]
  v_mfma_f32_16x16x32_bf16 v[184:187], a[28:31], a[80:83], v[184:187]
  v_cndmask_b32 v4, v4, v123, s[72:73]
  v_cndmask_b32 v5, v124, v125, s[64:65]
  v_mfma_f32_16x16x32_bf16 v[188:191], a[32:35], a[80:83], v[188:191]
  v_cndmask_b32 v5, v5, v126, s[66:67]
  v_mfma_f32_16x16x32_bf16 v[192:195], a[36:39], a[80:83], v[192:195]
  v_cndmask_b32 v5, v5, v127, s[72:73]
  ds_write_b32 v2, v112 offset:0
  v_mfma_f32_16x16x32_bf16 v[196:199], a[40:43], a[80:83], v[196:199]
  ds_write_b32 v7, v4 offset:4
  ds_write_b32 v2, v116 offset:128
  v_mfma_f32_16x16x32_bf16 v[200:203], a[44:47], a[80:83], v[200:203]
  ds_write_b32 v7, v5 offset:132
  ds_read_b128 v[56:59], v8 offset:0
  v_mfma_f32_16x16x32_bf16 v[204:207], a[48:51], a[80:83], v[204:207]
  ds_read_b128 v[60:63], v8 offset:448
  v_mfma_f32_16x16x32_bf16 v[208:211], a[52:55], a[80:83], v[208:211]
  ds_read_b128 v[64:67], v8 offset:32
  ds_read_b128 v[68:71], v8 offset:480
  v_mfma_f32_16x16x32_bf16 v[212:215], a[28:31], a[84:87], v[212:215]
  ds_read_b128 v[72:75], v8 offset:64
  ds_read_b128 v[76:79], v8 offset:512
  v_mfma_f32_16x16x32_bf16 v[216:219], a[32:35], a[84:87], v[216:219]
  ds_read_b128 v[80:83], v8 offset:96
  ds_read_b128 v[84:87], v8 offset:544
  v_mfma_f32_16x16x32_bf16 v[220:223], a[36:39], a[84:87], v[220:223]
  ds_read_b128 v[88:91], v8 offset:128
  v_mfma_f32_16x16x32_bf16 v[224:227], a[40:43], a[84:87], v[224:227]
  ds_read_b128 v[92:95], v8 offset:576
  ds_read_b128 v[96:99], v8 offset:160
  v_mfma_f32_16x16x32_bf16 v[228:231], a[44:47], a[84:87], v[228:231]
  ds_read_b128 v[100:103], v8 offset:608
  ds_read_b128 v[104:107], v8 offset:192
  v_mfma_f32_16x16x32_bf16 v[232:235], a[48:51], a[84:87], v[232:235]
  ds_read_b128 v[108:111], v8 offset:640
  v_mfma_f32_16x16x32_bf16 v[236:239], a[52:55], a[84:87], v[236:239]
  s_waitcnt lgkmcnt(0)
  s_barrier
  v_lshrrev_b32 v3, 5, v255
  v_and_b32 v4, 15, v255
  s_lshl_b32 s64, s80, 1
  s_lshl_b32 s65, s79, 2
  v_add_u32 v5, 0, v3
  v_xor_b32 v5, s64, v5
  v_add_u32 v5, s65, v5
  v_lshl_add_u32 v5, v5, 4, v4
  v_lshlrev_b32 v5, 3, v5
  v_add_u32 v5, 157184, v5
  ds_read_b64 v[6:7], v5
  v_add_u32 v5, 2, v3
  v_xor_b32 v5, s64, v5
  v_add_u32 v5, s65, v5
  v_lshl_add_u32 v5, v5, 4, v4
  v_lshlrev_b32 v5, 3, v5
  v_add_u32 v5, 157184, v5
  ds_read_b64 v[8:9], v5
  v_mov_b32 v10, 0x3b000000
  v_mov_b32 v11, 0x3727c5ac
  v_mov_b32 v12, 0xc0135761
  v_mov_b32 v13, 0x3d372713
  s_waitcnt lgkmcnt(0)
  v_mul_f32 v6, v6, v10
  v_mul_f32 v7, v7, v10
  v_fma_f32 v7, -v6, v6, v7
  v_max_f32 v7, 0, v7
  v_add_f32 v43, v7, v11
  v_rsq_f32 v14, v43
  v_sub_f32 v40, 0, v6
  v_mul_f32 v41, v12, v14
  v_mul_f32 v15, v14, v14
  v_mul_f32 v15, v15, v13
  v_mul_f32 v42, v41, v15
  v_mul_f32 v8, v8, v10
  v_mul_f32 v9, v9, v10
  v_fma_f32 v9, -v8, v8, v9
  v_max_f32 v9, 0, v9
  v_add_f32 v47, v9, v11
  v_rsq_f32 v14, v47
  v_sub_f32 v44, 0, v8
  v_mul_f32 v45, v12, v14
  v_mul_f32 v15, v14, v14
  v_mul_f32 v15, v15, v13
  v_mul_f32 v46, v45, v15
  s_mov_b32 s64, 9437184
  v_permlane32_swap_b32 v128, v156
  v_permlane32_swap_b32 v129, v157
  v_permlane32_swap_b32 v130, v158
  v_permlane32_swap_b32 v131, v159
  v_permlane32_swap_b32 v184, v212
  v_permlane32_swap_b32 v185, v213
  v_permlane32_swap_b32 v186, v214
  v_permlane32_swap_b32 v187, v215
  buffer_load_dwordx4 a[0:3], v38, s[44:47], s87 offen offset:1024 sc1
  v_pk_fma_f32 v[128:129], v[56:57], v[40:41], v[128:129] op_sel_hi:[1,0,1]
  v_pk_fma_f32 v[130:131], v[58:59], v[40:41], v[130:131] op_sel_hi:[1,0,1]
  v_pk_fma_f32 v[184:185], v[56:57], v[44:45], v[184:185] op_sel_hi:[1,0,1]
  v_pk_fma_f32 v[186:187], v[58:59], v[44:45], v[186:187] op_sel_hi:[1,0,1]
  v_pk_fma_f32 v[156:157], v[60:61], v[40:41], v[156:157] op_sel_hi:[1,0,1]
  v_pk_fma_f32 v[158:159], v[62:63], v[40:41], v[158:159] op_sel_hi:[1,0,1]
  v_pk_fma_f32 v[212:213], v[60:61], v[44:45], v[212:213] op_sel_hi:[1,0,1]
  v_pk_fma_f32 v[214:215], v[62:63], v[44:45], v[214:215] op_sel_hi:[1,0,1]
  v_pk_mul_f32 v[20:21], v[128:129], v[128:129]
  v_pk_mul_f32 v[24:25], v[130:131], v[130:131]
  v_pk_mul_f32 v[28:29], v[184:185], v[184:185]
  v_pk_mul_f32 v[32:33], v[186:187], v[186:187]
  v_pk_fma_f32 v[20:21], v[20:21], v[42:43], v[40:41] op_sel:[0,0,1] op_sel_hi:[1,0,1]
  v_pk_fma_f32 v[24:25], v[24:25], v[42:43], v[40:41] op_sel:[0,0,1] op_sel_hi:[1,0,1]
  v_pk_fma_f32 v[28:29], v[28:29], v[46:47], v[44:45] op_sel:[0,0,1] op_sel_hi:[1,0,1]
  v_pk_fma_f32 v[32:33], v[32:33], v[46:47], v[44:45] op_sel:[0,0,1] op_sel_hi:[1,0,1]
  v_pk_mul_f32 v[20:21], v[20:21], v[128:129]
  v_pk_mul_f32 v[24:25], v[24:25], v[130:131]
  v_pk_mul_f32 v[28:29], v[28:29], v[184:185]
  v_pk_mul_f32 v[32:33], v[32:33], v[186:187]
  v_exp_f32 v20, v20
  v_exp_f32 v21, v21
  v_exp_f32 v24, v24
  v_exp_f32 v25, v25
  v_exp_f32 v28, v28
  v_exp_f32 v29, v29
  v_exp_f32 v32, v32
  v_exp_f32 v33, v33
  buffer_load_dwordx4 a[4:7], v38, s[44:47], s87 offen offset:2048 sc1
  v_pk_mul_f32 v[22:23], v[128:129], v[156:157]
  v_pk_mul_f32 v[26:27], v[130:131], v[158:159]
  v_pk_mul_f32 v[30:31], v[184:185], v[212:213]
  v_pk_mul_f32 v[34:35], v[186:187], v[214:215]
  v_pk_fma_f32 v[20:21], v[20:21], v[42:43], v[42:43] op_sel:[0,1,1] op_sel_hi:[1,1,1]
  v_pk_fma_f32 v[24:25], v[24:25], v[42:43], v[42:43] op_sel:[0,1,1] op_sel_hi:[1,1,1]
  v_pk_fma_f32 v[28:29], v[28:29], v[46:47], v[46:47] op_sel:[0,1,1] op_sel_hi:[1,1,1]
  v_pk_fma_f32 v[32:33], v[32:33], v[46:47], v[46:47] op_sel:[0,1,1] op_sel_hi:[1,1,1]
  v_rcp_f32 v20, v20
  v_rcp_f32 v21, v21
  v_rcp_f32 v24, v24
  v_rcp_f32 v25, v25
  v_rcp_f32 v28, v28
  v_rcp_f32 v29, v29
  v_rcp_f32 v32, v32
  v_rcp_f32 v33, v33
  v_pk_mul_f32 v[20:21], v[20:21], v[22:23]
  v_pk_mul_f32 v[24:25], v[24:25], v[26:27]
  v_pk_mul_f32 v[28:29], v[28:29], v[30:31]
  v_pk_mul_f32 v[32:33], v[32:33], v[34:35]
  v_cvt_pk_bf16_f32 v128, v20, v21
  v_cvt_pk_bf16_f32 v129, v24, v25
  v_cvt_pk_bf16_f32 v184, v28, v29
  v_cvt_pk_bf16_f32 v185, v32, v33
  buffer_store_dwordx2 v[128:129], v240, s[44:47], s64 offen offset:0 sc1
  buffer_store_dwordx2 v[184:185], v241, s[44:47], s64 offen offset:0 sc1
  v_permlane32_swap_b32 v132, v160
  v_permlane32_swap_b32 v133, v161
  v_permlane32_swap_b32 v134, v162
  v_permlane32_swap_b32 v135, v163
  v_permlane32_swap_b32 v188, v216
  v_permlane32_swap_b32 v189, v217
  v_permlane32_swap_b32 v190, v218
  v_permlane32_swap_b32 v191, v219
  buffer_load_dwordx4 a[8:11], v38, s[44:47], s87 offen offset:3072 sc1
  v_pk_fma_f32 v[132:133], v[64:65], v[40:41], v[132:133] op_sel_hi:[1,0,1]
  v_pk_fma_f32 v[134:135], v[66:67], v[40:41], v[134:135] op_sel_hi:[1,0,1]
  v_pk_fma_f32 v[188:189], v[64:65], v[44:45], v[188:189] op_sel_hi:[1,0,1]
  v_pk_fma_f32 v[190:191], v[66:67], v[44:45], v[190:191] op_sel_hi:[1,0,1]
  v_pk_fma_f32 v[160:161], v[68:69], v[40:41], v[160:161] op_sel_hi:[1,0,1]
  v_pk_fma_f32 v[162:163], v[70:71], v[40:41], v[162:163] op_sel_hi:[1,0,1]
  v_pk_fma_f32 v[216:217], v[68:69], v[44:45], v[216:217] op_sel_hi:[1,0,1]
  v_pk_fma_f32 v[218:219], v[70:71], v[44:45], v[218:219] op_sel_hi:[1,0,1]
  v_pk_mul_f32 v[20:21], v[132:133], v[132:133]
  v_pk_mul_f32 v[24:25], v[134:135], v[134:135]
  v_pk_mul_f32 v[28:29], v[188:189], v[188:189]
  v_pk_mul_f32 v[32:33], v[190:191], v[190:191]
  v_pk_fma_f32 v[20:21], v[20:21], v[42:43], v[40:41] op_sel:[0,0,1] op_sel_hi:[1,0,1]
  v_pk_fma_f32 v[24:25], v[24:25], v[42:43], v[40:41] op_sel:[0,0,1] op_sel_hi:[1,0,1]
  v_pk_fma_f32 v[28:29], v[28:29], v[46:47], v[44:45] op_sel:[0,0,1] op_sel_hi:[1,0,1]
  v_pk_fma_f32 v[32:33], v[32:33], v[46:47], v[44:45] op_sel:[0,0,1] op_sel_hi:[1,0,1]
  v_pk_mul_f32 v[20:21], v[20:21], v[132:133]
  v_pk_mul_f32 v[24:25], v[24:25], v[134:135]
  v_pk_mul_f32 v[28:29], v[28:29], v[188:189]
  v_pk_mul_f32 v[32:33], v[32:33], v[190:191]
  v_exp_f32 v20, v20
  v_exp_f32 v21, v21
  v_exp_f32 v24, v24
  v_exp_f32 v25, v25
  v_exp_f32 v28, v28
  v_exp_f32 v29, v29
  v_exp_f32 v32, v32
  v_exp_f32 v33, v33
  s_add_u32 s87, s87, 32768
  buffer_load_dwordx4 a[12:15], v38, s[44:47], s87 offen offset:0 sc1
  v_pk_mul_f32 v[22:23], v[132:133], v[160:161]
  v_pk_mul_f32 v[26:27], v[134:135], v[162:163]
  v_pk_mul_f32 v[30:31], v[188:189], v[216:217]
  v_pk_mul_f32 v[34:35], v[190:191], v[218:219]
  v_pk_fma_f32 v[20:21], v[20:21], v[42:43], v[42:43] op_sel:[0,1,1] op_sel_hi:[1,1,1]
  v_pk_fma_f32 v[24:25], v[24:25], v[42:43], v[42:43] op_sel:[0,1,1] op_sel_hi:[1,1,1]
  v_pk_fma_f32 v[28:29], v[28:29], v[46:47], v[46:47] op_sel:[0,1,1] op_sel_hi:[1,1,1]
  v_pk_fma_f32 v[32:33], v[32:33], v[46:47], v[46:47] op_sel:[0,1,1] op_sel_hi:[1,1,1]
  v_rcp_f32 v20, v20
  v_rcp_f32 v21, v21
  v_rcp_f32 v24, v24
  v_rcp_f32 v25, v25
  v_rcp_f32 v28, v28
  v_rcp_f32 v29, v29
  v_rcp_f32 v32, v32
  v_rcp_f32 v33, v33
  v_pk_mul_f32 v[20:21], v[20:21], v[22:23]
  v_pk_mul_f32 v[24:25], v[24:25], v[26:27]
  v_pk_mul_f32 v[28:29], v[28:29], v[30:31]
  v_pk_mul_f32 v[32:33], v[32:33], v[34:35]
  v_cvt_pk_bf16_f32 v132, v20, v21
  v_cvt_pk_bf16_f32 v133, v24, v25
  v_cvt_pk_bf16_f32 v188, v28, v29
  v_cvt_pk_bf16_f32 v189, v32, v33
  buffer_store_dwordx2 v[132:133], v240, s[44:47], s64 offen offset:256 sc1
  buffer_store_dwordx2 v[188:189], v241, s[44:47], s64 offen offset:256 sc1
  v_permlane32_swap_b32 v136, v164
  v_permlane32_swap_b32 v137, v165
  v_permlane32_swap_b32 v138, v166
  v_permlane32_swap_b32 v139, v167
  v_permlane32_swap_b32 v192, v220
  v_permlane32_swap_b32 v193, v221
  v_permlane32_swap_b32 v194, v222
  v_permlane32_swap_b32 v195, v223
  buffer_load_dwordx4 a[16:19], v38, s[44:47], s87 offen offset:1024 sc1
  v_pk_fma_f32 v[136:137], v[72:73], v[40:41], v[136:137] op_sel_hi:[1,0,1]
  v_pk_fma_f32 v[138:139], v[74:75], v[40:41], v[138:139] op_sel_hi:[1,0,1]
  v_pk_fma_f32 v[192:193], v[72:73], v[44:45], v[192:193] op_sel_hi:[1,0,1]
  v_pk_fma_f32 v[194:195], v[74:75], v[44:45], v[194:195] op_sel_hi:[1,0,1]
  v_pk_fma_f32 v[164:165], v[76:77], v[40:41], v[164:165] op_sel_hi:[1,0,1]
  v_pk_fma_f32 v[166:167], v[78:79], v[40:41], v[166:167] op_sel_hi:[1,0,1]
  v_pk_fma_f32 v[220:221], v[76:77], v[44:45], v[220:221] op_sel_hi:[1,0,1]
  v_pk_fma_f32 v[222:223], v[78:79], v[44:45], v[222:223] op_sel_hi:[1,0,1]
  v_pk_mul_f32 v[20:21], v[136:137], v[136:137]
  v_pk_mul_f32 v[24:25], v[138:139], v[138:139]
  v_pk_mul_f32 v[28:29], v[192:193], v[192:193]
  v_pk_mul_f32 v[32:33], v[194:195], v[194:195]
  v_pk_fma_f32 v[20:21], v[20:21], v[42:43], v[40:41] op_sel:[0,0,1] op_sel_hi:[1,0,1]
  v_pk_fma_f32 v[24:25], v[24:25], v[42:43], v[40:41] op_sel:[0,0,1] op_sel_hi:[1,0,1]
  v_pk_fma_f32 v[28:29], v[28:29], v[46:47], v[44:45] op_sel:[0,0,1] op_sel_hi:[1,0,1]
  v_pk_fma_f32 v[32:33], v[32:33], v[46:47], v[44:45] op_sel:[0,0,1] op_sel_hi:[1,0,1]
  v_pk_mul_f32 v[20:21], v[20:21], v[136:137]
  v_pk_mul_f32 v[24:25], v[24:25], v[138:139]
  v_pk_mul_f32 v[28:29], v[28:29], v[192:193]
  v_pk_mul_f32 v[32:33], v[32:33], v[194:195]
  v_exp_f32 v20, v20
  v_exp_f32 v21, v21
  v_exp_f32 v24, v24
  v_exp_f32 v25, v25
  v_exp_f32 v28, v28
  v_exp_f32 v29, v29
  v_exp_f32 v32, v32
  v_exp_f32 v33, v33
  buffer_load_dwordx4 a[20:23], v38, s[44:47], s87 offen offset:2048 sc1
  v_pk_mul_f32 v[22:23], v[136:137], v[164:165]
  v_pk_mul_f32 v[26:27], v[138:139], v[166:167]
  v_pk_mul_f32 v[30:31], v[192:193], v[220:221]
  v_pk_mul_f32 v[34:35], v[194:195], v[222:223]
  v_pk_fma_f32 v[20:21], v[20:21], v[42:43], v[42:43] op_sel:[0,1,1] op_sel_hi:[1,1,1]
  v_pk_fma_f32 v[24:25], v[24:25], v[42:43], v[42:43] op_sel:[0,1,1] op_sel_hi:[1,1,1]
  v_pk_fma_f32 v[28:29], v[28:29], v[46:47], v[46:47] op_sel:[0,1,1] op_sel_hi:[1,1,1]
  v_pk_fma_f32 v[32:33], v[32:33], v[46:47], v[46:47] op_sel:[0,1,1] op_sel_hi:[1,1,1]
  v_rcp_f32 v20, v20
  v_rcp_f32 v21, v21
  v_rcp_f32 v24, v24
  v_rcp_f32 v25, v25
  v_rcp_f32 v28, v28
  v_rcp_f32 v29, v29
  v_rcp_f32 v32, v32
  v_rcp_f32 v33, v33
  v_pk_mul_f32 v[20:21], v[20:21], v[22:23]
  v_pk_mul_f32 v[24:25], v[24:25], v[26:27]
  v_pk_mul_f32 v[28:29], v[28:29], v[30:31]
  v_pk_mul_f32 v[32:33], v[32:33], v[34:35]
  v_cvt_pk_bf16_f32 v136, v20, v21
  v_cvt_pk_bf16_f32 v137, v24, v25
  v_cvt_pk_bf16_f32 v192, v28, v29
  v_cvt_pk_bf16_f32 v193, v32, v33
  buffer_store_dwordx2 v[136:137], v240, s[44:47], s64 offen offset:512 sc1
  buffer_store_dwordx2 v[192:193], v241, s[44:47], s64 offen offset:512 sc1
  v_permlane32_swap_b32 v140, v168
  v_permlane32_swap_b32 v141, v169
  v_permlane32_swap_b32 v142, v170
  v_permlane32_swap_b32 v143, v171
  v_permlane32_swap_b32 v196, v224
  v_permlane32_swap_b32 v197, v225
  v_permlane32_swap_b32 v198, v226
  v_permlane32_swap_b32 v199, v227
  buffer_load_dwordx4 a[24:27], v38, s[44:47], s87 offen offset:3072 sc1
  v_pk_fma_f32 v[140:141], v[80:81], v[40:41], v[140:141] op_sel_hi:[1,0,1]
  v_pk_fma_f32 v[142:143], v[82:83], v[40:41], v[142:143] op_sel_hi:[1,0,1]
  v_pk_fma_f32 v[196:197], v[80:81], v[44:45], v[196:197] op_sel_hi:[1,0,1]
  v_pk_fma_f32 v[198:199], v[82:83], v[44:45], v[198:199] op_sel_hi:[1,0,1]
  v_pk_fma_f32 v[168:169], v[84:85], v[40:41], v[168:169] op_sel_hi:[1,0,1]
  v_pk_fma_f32 v[170:171], v[86:87], v[40:41], v[170:171] op_sel_hi:[1,0,1]
  v_pk_fma_f32 v[224:225], v[84:85], v[44:45], v[224:225] op_sel_hi:[1,0,1]
  v_pk_fma_f32 v[226:227], v[86:87], v[44:45], v[226:227] op_sel_hi:[1,0,1]
  v_pk_mul_f32 v[20:21], v[140:141], v[140:141]
  v_pk_mul_f32 v[24:25], v[142:143], v[142:143]
  v_pk_mul_f32 v[28:29], v[196:197], v[196:197]
  v_pk_mul_f32 v[32:33], v[198:199], v[198:199]
  v_pk_fma_f32 v[20:21], v[20:21], v[42:43], v[40:41] op_sel:[0,0,1] op_sel_hi:[1,0,1]
  v_pk_fma_f32 v[24:25], v[24:25], v[42:43], v[40:41] op_sel:[0,0,1] op_sel_hi:[1,0,1]
  v_pk_fma_f32 v[28:29], v[28:29], v[46:47], v[44:45] op_sel:[0,0,1] op_sel_hi:[1,0,1]
  v_pk_fma_f32 v[32:33], v[32:33], v[46:47], v[44:45] op_sel:[0,0,1] op_sel_hi:[1,0,1]
  v_pk_mul_f32 v[20:21], v[20:21], v[140:141]
  v_pk_mul_f32 v[24:25], v[24:25], v[142:143]
  v_pk_mul_f32 v[28:29], v[28:29], v[196:197]
  v_pk_mul_f32 v[32:33], v[32:33], v[198:199]
  v_exp_f32 v20, v20
  v_exp_f32 v21, v21
  v_exp_f32 v24, v24
  v_exp_f32 v25, v25
  v_exp_f32 v28, v28
  v_exp_f32 v29, v29
  v_exp_f32 v32, v32
  v_exp_f32 v33, v33
  s_add_u32 s87, s87, 32768
  buffer_load_dwordx4 a[28:31], v38, s[44:47], s87 offen offset:0 sc1
  v_pk_mul_f32 v[22:23], v[140:141], v[168:169]
  v_pk_mul_f32 v[26:27], v[142:143], v[170:171]
  v_pk_mul_f32 v[30:31], v[196:197], v[224:225]
  v_pk_mul_f32 v[34:35], v[198:199], v[226:227]
  v_pk_fma_f32 v[20:21], v[20:21], v[42:43], v[42:43] op_sel:[0,1,1] op_sel_hi:[1,1,1]
  v_pk_fma_f32 v[24:25], v[24:25], v[42:43], v[42:43] op_sel:[0,1,1] op_sel_hi:[1,1,1]
  v_pk_fma_f32 v[28:29], v[28:29], v[46:47], v[46:47] op_sel:[0,1,1] op_sel_hi:[1,1,1]
  v_pk_fma_f32 v[32:33], v[32:33], v[46:47], v[46:47] op_sel:[0,1,1] op_sel_hi:[1,1,1]
  v_rcp_f32 v20, v20
  v_rcp_f32 v21, v21
  v_rcp_f32 v24, v24
  v_rcp_f32 v25, v25
  v_rcp_f32 v28, v28
  v_rcp_f32 v29, v29
  v_rcp_f32 v32, v32
  v_rcp_f32 v33, v33
  v_pk_mul_f32 v[20:21], v[20:21], v[22:23]
  v_pk_mul_f32 v[24:25], v[24:25], v[26:27]
  v_pk_mul_f32 v[28:29], v[28:29], v[30:31]
  v_pk_mul_f32 v[32:33], v[32:33], v[34:35]
  v_cvt_pk_bf16_f32 v140, v20, v21
  v_cvt_pk_bf16_f32 v141, v24, v25
  v_cvt_pk_bf16_f32 v196, v28, v29
  v_cvt_pk_bf16_f32 v197, v32, v33
  buffer_store_dwordx2 v[140:141], v240, s[44:47], s64 offen offset:768 sc1
  buffer_store_dwordx2 v[196:197], v241, s[44:47], s64 offen offset:768 sc1
  v_permlane32_swap_b32 v144, v172
  v_permlane32_swap_b32 v145, v173
  v_permlane32_swap_b32 v146, v174
  v_permlane32_swap_b32 v147, v175
  v_permlane32_swap_b32 v200, v228
  v_permlane32_swap_b32 v201, v229
  v_permlane32_swap_b32 v202, v230
  v_permlane32_swap_b32 v203, v231
  buffer_load_dwordx4 a[32:35], v38, s[44:47], s87 offen offset:1024 sc1
  v_pk_fma_f32 v[144:145], v[88:89], v[40:41], v[144:145] op_sel_hi:[1,0,1]
  v_pk_fma_f32 v[146:147], v[90:91], v[40:41], v[146:147] op_sel_hi:[1,0,1]
  v_pk_fma_f32 v[200:201], v[88:89], v[44:45], v[200:201] op_sel_hi:[1,0,1]
  v_pk_fma_f32 v[202:203], v[90:91], v[44:45], v[202:203] op_sel_hi:[1,0,1]
  v_pk_fma_f32 v[172:173], v[92:93], v[40:41], v[172:173] op_sel_hi:[1,0,1]
  v_pk_fma_f32 v[174:175], v[94:95], v[40:41], v[174:175] op_sel_hi:[1,0,1]
  v_pk_fma_f32 v[228:229], v[92:93], v[44:45], v[228:229] op_sel_hi:[1,0,1]
  v_pk_fma_f32 v[230:231], v[94:95], v[44:45], v[230:231] op_sel_hi:[1,0,1]
  v_pk_mul_f32 v[20:21], v[144:145], v[144:145]
  v_pk_mul_f32 v[24:25], v[146:147], v[146:147]
  v_pk_mul_f32 v[28:29], v[200:201], v[200:201]
  v_pk_mul_f32 v[32:33], v[202:203], v[202:203]
  v_pk_fma_f32 v[20:21], v[20:21], v[42:43], v[40:41] op_sel:[0,0,1] op_sel_hi:[1,0,1]
  v_pk_fma_f32 v[24:25], v[24:25], v[42:43], v[40:41] op_sel:[0,0,1] op_sel_hi:[1,0,1]
  v_pk_fma_f32 v[28:29], v[28:29], v[46:47], v[44:45] op_sel:[0,0,1] op_sel_hi:[1,0,1]
  v_pk_fma_f32 v[32:33], v[32:33], v[46:47], v[44:45] op_sel:[0,0,1] op_sel_hi:[1,0,1]
  v_pk_mul_f32 v[20:21], v[20:21], v[144:145]
  v_pk_mul_f32 v[24:25], v[24:25], v[146:147]
  v_pk_mul_f32 v[28:29], v[28:29], v[200:201]
  v_pk_mul_f32 v[32:33], v[32:33], v[202:203]
  v_exp_f32 v20, v20
  v_exp_f32 v21, v21
  v_exp_f32 v24, v24
  v_exp_f32 v25, v25
  v_exp_f32 v28, v28
  v_exp_f32 v29, v29
  v_exp_f32 v32, v32
  v_exp_f32 v33, v33
  buffer_load_dwordx4 a[36:39], v38, s[44:47], s87 offen offset:2048 sc1
  v_pk_mul_f32 v[22:23], v[144:145], v[172:173]
  v_pk_mul_f32 v[26:27], v[146:147], v[174:175]
  v_pk_mul_f32 v[30:31], v[200:201], v[228:229]
  v_pk_mul_f32 v[34:35], v[202:203], v[230:231]
  v_pk_fma_f32 v[20:21], v[20:21], v[42:43], v[42:43] op_sel:[0,1,1] op_sel_hi:[1,1,1]
  v_pk_fma_f32 v[24:25], v[24:25], v[42:43], v[42:43] op_sel:[0,1,1] op_sel_hi:[1,1,1]
  v_pk_fma_f32 v[28:29], v[28:29], v[46:47], v[46:47] op_sel:[0,1,1] op_sel_hi:[1,1,1]
  v_pk_fma_f32 v[32:33], v[32:33], v[46:47], v[46:47] op_sel:[0,1,1] op_sel_hi:[1,1,1]
  v_rcp_f32 v20, v20
  v_rcp_f32 v21, v21
  v_rcp_f32 v24, v24
  v_rcp_f32 v25, v25
  v_rcp_f32 v28, v28
  v_rcp_f32 v29, v29
  v_rcp_f32 v32, v32
  v_rcp_f32 v33, v33
  v_pk_mul_f32 v[20:21], v[20:21], v[22:23]
  v_pk_mul_f32 v[24:25], v[24:25], v[26:27]
  v_pk_mul_f32 v[28:29], v[28:29], v[30:31]
  v_pk_mul_f32 v[32:33], v[32:33], v[34:35]
  v_cvt_pk_bf16_f32 v144, v20, v21
  v_cvt_pk_bf16_f32 v145, v24, v25
  v_cvt_pk_bf16_f32 v200, v28, v29
  v_cvt_pk_bf16_f32 v201, v32, v33
  buffer_store_dwordx2 v[144:145], v240, s[44:47], s64 offen offset:1024 sc1
  buffer_store_dwordx2 v[200:201], v241, s[44:47], s64 offen offset:1024 sc1
  v_permlane32_swap_b32 v148, v176
  v_permlane32_swap_b32 v149, v177
  v_permlane32_swap_b32 v150, v178
  v_permlane32_swap_b32 v151, v179
  v_permlane32_swap_b32 v204, v232
  v_permlane32_swap_b32 v205, v233
  v_permlane32_swap_b32 v206, v234
  v_permlane32_swap_b32 v207, v235
  buffer_load_dwordx4 a[40:43], v38, s[44:47], s87 offen offset:3072 sc1
  v_pk_fma_f32 v[148:149], v[96:97], v[40:41], v[148:149] op_sel_hi:[1,0,1]
  v_pk_fma_f32 v[150:151], v[98:99], v[40:41], v[150:151] op_sel_hi:[1,0,1]
  v_pk_fma_f32 v[204:205], v[96:97], v[44:45], v[204:205] op_sel_hi:[1,0,1]
  v_pk_fma_f32 v[206:207], v[98:99], v[44:45], v[206:207] op_sel_hi:[1,0,1]
  v_pk_fma_f32 v[176:177], v[100:101], v[40:41], v[176:177] op_sel_hi:[1,0,1]
  v_pk_fma_f32 v[178:179], v[102:103], v[40:41], v[178:179] op_sel_hi:[1,0,1]
  v_pk_fma_f32 v[232:233], v[100:101], v[44:45], v[232:233] op_sel_hi:[1,0,1]
  v_pk_fma_f32 v[234:235], v[102:103], v[44:45], v[234:235] op_sel_hi:[1,0,1]
  v_pk_mul_f32 v[20:21], v[148:149], v[148:149]
  v_pk_mul_f32 v[24:25], v[150:151], v[150:151]
  v_pk_mul_f32 v[28:29], v[204:205], v[204:205]
  v_pk_mul_f32 v[32:33], v[206:207], v[206:207]
  v_pk_fma_f32 v[20:21], v[20:21], v[42:43], v[40:41] op_sel:[0,0,1] op_sel_hi:[1,0,1]
  v_pk_fma_f32 v[24:25], v[24:25], v[42:43], v[40:41] op_sel:[0,0,1] op_sel_hi:[1,0,1]
  v_pk_fma_f32 v[28:29], v[28:29], v[46:47], v[44:45] op_sel:[0,0,1] op_sel_hi:[1,0,1]
  v_pk_fma_f32 v[32:33], v[32:33], v[46:47], v[44:45] op_sel:[0,0,1] op_sel_hi:[1,0,1]
  v_pk_mul_f32 v[20:21], v[20:21], v[148:149]
  v_pk_mul_f32 v[24:25], v[24:25], v[150:151]
  v_pk_mul_f32 v[28:29], v[28:29], v[204:205]
  v_pk_mul_f32 v[32:33], v[32:33], v[206:207]
  v_exp_f32 v20, v20
  v_exp_f32 v21, v21
  v_exp_f32 v24, v24
  v_exp_f32 v25, v25
  v_exp_f32 v28, v28
  v_exp_f32 v29, v29
  v_exp_f32 v32, v32
  v_exp_f32 v33, v33
  s_add_u32 s87, s87, 32768
  buffer_load_dwordx4 a[44:47], v38, s[44:47], s87 offen offset:0 sc1
  v_pk_mul_f32 v[22:23], v[148:149], v[176:177]
  v_pk_mul_f32 v[26:27], v[150:151], v[178:179]
  v_pk_mul_f32 v[30:31], v[204:205], v[232:233]
  v_pk_mul_f32 v[34:35], v[206:207], v[234:235]
  v_pk_fma_f32 v[20:21], v[20:21], v[42:43], v[42:43] op_sel:[0,1,1] op_sel_hi:[1,1,1]
  v_pk_fma_f32 v[24:25], v[24:25], v[42:43], v[42:43] op_sel:[0,1,1] op_sel_hi:[1,1,1]
  v_pk_fma_f32 v[28:29], v[28:29], v[46:47], v[46:47] op_sel:[0,1,1] op_sel_hi:[1,1,1]
  v_pk_fma_f32 v[32:33], v[32:33], v[46:47], v[46:47] op_sel:[0,1,1] op_sel_hi:[1,1,1]
  v_rcp_f32 v20, v20
  v_rcp_f32 v21, v21
  v_rcp_f32 v24, v24
  v_rcp_f32 v25, v25
  v_rcp_f32 v28, v28
  v_rcp_f32 v29, v29
  v_rcp_f32 v32, v32
  v_rcp_f32 v33, v33
  v_pk_mul_f32 v[20:21], v[20:21], v[22:23]
  v_pk_mul_f32 v[24:25], v[24:25], v[26:27]
  v_pk_mul_f32 v[28:29], v[28:29], v[30:31]
  v_pk_mul_f32 v[32:33], v[32:33], v[34:35]
  v_cvt_pk_bf16_f32 v148, v20, v21
  v_cvt_pk_bf16_f32 v149, v24, v25
  v_cvt_pk_bf16_f32 v204, v28, v29
  v_cvt_pk_bf16_f32 v205, v32, v33
  buffer_store_dwordx2 v[148:149], v240, s[44:47], s64 offen offset:1280 sc1
  buffer_store_dwordx2 v[204:205], v241, s[44:47], s64 offen offset:1280 sc1
  v_permlane32_swap_b32 v152, v180
  v_permlane32_swap_b32 v153, v181
  v_permlane32_swap_b32 v154, v182
  v_permlane32_swap_b32 v155, v183
  v_permlane32_swap_b32 v208, v236
  v_permlane32_swap_b32 v209, v237
  v_permlane32_swap_b32 v210, v238
  v_permlane32_swap_b32 v211, v239
  buffer_load_dwordx4 a[48:51], v38, s[44:47], s87 offen offset:1024 sc1
  v_pk_fma_f32 v[152:153], v[104:105], v[40:41], v[152:153] op_sel_hi:[1,0,1]
  v_pk_fma_f32 v[154:155], v[106:107], v[40:41], v[154:155] op_sel_hi:[1,0,1]
  v_pk_fma_f32 v[208:209], v[104:105], v[44:45], v[208:209] op_sel_hi:[1,0,1]
  v_pk_fma_f32 v[210:211], v[106:107], v[44:45], v[210:211] op_sel_hi:[1,0,1]
  v_pk_fma_f32 v[180:181], v[108:109], v[40:41], v[180:181] op_sel_hi:[1,0,1]
  v_pk_fma_f32 v[182:183], v[110:111], v[40:41], v[182:183] op_sel_hi:[1,0,1]
  v_pk_fma_f32 v[236:237], v[108:109], v[44:45], v[236:237] op_sel_hi:[1,0,1]
  v_pk_fma_f32 v[238:239], v[110:111], v[44:45], v[238:239] op_sel_hi:[1,0,1]
  v_pk_mul_f32 v[20:21], v[152:153], v[152:153]
  v_pk_mul_f32 v[24:25], v[154:155], v[154:155]
  v_pk_mul_f32 v[28:29], v[208:209], v[208:209]
  v_pk_mul_f32 v[32:33], v[210:211], v[210:211]
  v_pk_fma_f32 v[20:21], v[20:21], v[42:43], v[40:41] op_sel:[0,0,1] op_sel_hi:[1,0,1]
  v_pk_fma_f32 v[24:25], v[24:25], v[42:43], v[40:41] op_sel:[0,0,1] op_sel_hi:[1,0,1]
  v_pk_fma_f32 v[28:29], v[28:29], v[46:47], v[44:45] op_sel:[0,0,1] op_sel_hi:[1,0,1]
  v_pk_fma_f32 v[32:33], v[32:33], v[46:47], v[44:45] op_sel:[0,0,1] op_sel_hi:[1,0,1]
  v_pk_mul_f32 v[20:21], v[20:21], v[152:153]
  v_pk_mul_f32 v[24:25], v[24:25], v[154:155]
  v_pk_mul_f32 v[28:29], v[28:29], v[208:209]
  v_pk_mul_f32 v[32:33], v[32:33], v[210:211]
  v_exp_f32 v20, v20
  v_exp_f32 v21, v21
  v_exp_f32 v24, v24
  v_exp_f32 v25, v25
  v_exp_f32 v28, v28
  v_exp_f32 v29, v29
  v_exp_f32 v32, v32
  v_exp_f32 v33, v33
  buffer_load_dwordx4 a[52:55], v38, s[44:47], s87 offen offset:2048 sc1
  v_pk_mul_f32 v[22:23], v[152:153], v[180:181]
  v_pk_mul_f32 v[26:27], v[154:155], v[182:183]
  v_pk_mul_f32 v[30:31], v[208:209], v[236:237]
  v_pk_mul_f32 v[34:35], v[210:211], v[238:239]
  v_pk_fma_f32 v[20:21], v[20:21], v[42:43], v[42:43] op_sel:[0,1,1] op_sel_hi:[1,1,1]
  v_pk_fma_f32 v[24:25], v[24:25], v[42:43], v[42:43] op_sel:[0,1,1] op_sel_hi:[1,1,1]
  v_pk_fma_f32 v[28:29], v[28:29], v[46:47], v[46:47] op_sel:[0,1,1] op_sel_hi:[1,1,1]
  v_pk_fma_f32 v[32:33], v[32:33], v[46:47], v[46:47] op_sel:[0,1,1] op_sel_hi:[1,1,1]
  v_rcp_f32 v20, v20
  v_rcp_f32 v21, v21
  v_rcp_f32 v24, v24
  v_rcp_f32 v25, v25
  v_rcp_f32 v28, v28
  v_rcp_f32 v29, v29
  v_rcp_f32 v32, v32
  v_rcp_f32 v33, v33
  buffer_load_dwordx4 a[56:59], v38, s[44:47], s87 offen offset:3072 sc1
  v_pk_mul_f32 v[20:21], v[20:21], v[22:23]
  v_pk_mul_f32 v[24:25], v[24:25], v[26:27]
  v_pk_mul_f32 v[28:29], v[28:29], v[30:31]
  v_pk_mul_f32 v[32:33], v[32:33], v[34:35]
  v_cvt_pk_bf16_f32 v152, v20, v21
  v_cvt_pk_bf16_f32 v153, v24, v25
  v_cvt_pk_bf16_f32 v208, v28, v29
  v_cvt_pk_bf16_f32 v209, v32, v33
  buffer_store_dwordx2 v[152:153], v240, s[44:47], s64 offen offset:1536 sc1
  buffer_store_dwordx2 v[208:209], v241, s[44:47], s64 offen offset:1536 sc1
  s_waitcnt vmcnt(0)
  s_barrier
  s_lshl_b32 s53, s77, 4
  s_add_u32 s53, s53, s78
  s_cmp_lg_u32 s50, 0
  s_cbranch_scc1 L_fs_21
  s_lshr_b32 s3, s53, 1
  s_lshl_b32 s3, s3, 7
  s_and_b32 s101, s53, 1
  s_lshl_b32 s101, s101, 6
  s_add_u32 s3, s3, s101
  s_add_u32 s3, s3, 98304
  v_mov_b32 v250, s54
  v_mov_b32 v251, s55
  v_mov_b32 v252, 0
  s_mov_b64 exec, 1
  buffer_store_dwordx2 v[250:251], v252, s[44:47], s3 offen sc1
  s_mov_b64 exec, -1
L_fs_21:
  v_lshrrev_b32 v3, 1, v255
  v_and_b32 v4, 1, v255
  v_lshlrev_b32 v3, 12, v3
  v_lshl_add_u32 v3, v4, 4, v3
  s_lshl_b32 s64, s86, 18
  s_lshl_b32 s65, s85, 7
  s_add_u32 s64, s64, s65
  s_lshl_b32 s65, s50, 5
  s_add_u32 s64, s64, s65
  s_add_u32 s64, s64, 5242880
  s_add_u32 s65, s64, 131072
  s_lshl_b32 s66, s50, 11
  s_add_u32 s66, s66, 49152
  s_mov_b32 m0, s66
  s_nop 0
  buffer_load_dwordx4 v3, s[44:47], s64 offen sc1 lds
  s_add_u32 m0, s66, 1024
  s_nop 0
  buffer_load_dwordx4 v3, s[44:47], s65 offen sc1 lds
  v_and_b32 v12, 15, v255
  v_lshrrev_b32 v13, 4, v255
  v_lshlrev_b32 v14, 3, v13
  v_sub_u32 v14, v12, v14
  v_mov_b32 v15, 0x3f80
  v_mov_b32 v240, 0x3f800000
  v_cmp_eq_u32 vcc, 0, v14
  s_nop 1
  v_cndmask_b32 v241, 0, v15, vcc
  v_cmp_eq_u32 vcc, 1, v14
  s_nop 1
  v_cndmask_b32 v244, v241, v240, vcc
  v_cmp_eq_u32 vcc, 2, v14
  s_nop 1
  v_cndmask_b32 v241, 0, v15, vcc
  v_cmp_eq_u32 vcc, 3, v14
  s_nop 1
  v_cndmask_b32 v245, v241, v240, vcc
  v_cmp_eq_u32 vcc, 4, v14
  s_nop 1
  v_cndmask_b32 v241, 0, v15, vcc
  v_cmp_eq_u32 vcc, 5, v14
  s_nop 1
  v_cndmask_b32 v246, v241, v240, vcc
  v_cmp_eq_u32 vcc, 6, v14
  s_nop 1
  v_cndmask_b32 v241, 0, v15, vcc
  v_cmp_eq_u32 vcc, 7, v14
  s_nop 1
  v_cndmask_b32 v247, v241, v240, vcc
  v_cmp_eq_u32 vcc, -16, v14
  s_nop 1
  v_cndmask_b32 v241, 0, v15, vcc
  v_cmp_eq_u32 vcc, -15, v14
  s_nop 1
  v_cndmask_b32 v4, v241, v240, vcc
  v_cmp_eq_u32 vcc, -14, v14
  s_nop 1
  v_cndmask_b32 v241, 0, v15, vcc
  v_cmp_eq_u32 vcc, -13, v14
  s_nop 1
  v_cndmask_b32 v5, v241, v240, vcc
  v_cmp_eq_u32 vcc, -12, v14
  s_nop 1
  v_cndmask_b32 v241, 0, v15, vcc
  v_cmp_eq_u32 vcc, -11, v14
  s_nop 1
  v_cndmask_b32 v6, v241, v240, vcc
  v_cmp_eq_u32 vcc, -10, v14
  s_nop 1
  v_cndmask_b32 v241, 0, v15, vcc
  v_cmp_eq_u32 vcc, -9, v14
  s_nop 1
  v_cndmask_b32 v7, v241, v240, vcc
  s_lshr_b32 s64, s85, 1
  s_lshl_b32 s64, s64, 4
  s_lshl_b32 s65, s50, 2
  s_add_u32 s64, s64, s65
  v_add_u32 v12, s64, v255
  v_lshrrev_b32 v3, 1, v12
  v_lshlrev_b32 v3, 7, v3
  v_and_b32 v12, 1, v12
  v_lshl_add_u32 v3, v12, 6, v3
  v_add_u32 v3, 98304, v3
  s_mov_b32 s3, 0
  s_bfm_b64 exec, 4, 0
L_poll_22:
  buffer_load_dwordx2 v[236:237], v3, s[44:47], 0 offen sc1
  s_add_u32 s3, s3, 1
  s_waitcnt vmcnt(0)
  v_cmp_ne_u64 vcc, s[54:55], v[236:237]
  s_cmp_ge_u32 s3, 1048576
  s_cbranch_scc1 L_polld_23
  s_nop 0
  s_and_b64 exec, exec, vcc
  s_cbranch_execz L_polld_23
  s_branch L_poll_22
L_polld_23:
  s_mov_b64 exec, -1
  s_mul_i32 s64, s50, 14336
  s_add_u32 s64, s64, 9437184
  s_lshl_b32 s65, s85, 2
  v_lshlrev_b32 v2, 4, v255
  s_mov_b32 s98, 0
  s_add_u32 s99, s98, 0
  s_cmp_ge_u32 s99, 3
  s_cselect_b32 s3, 3, 0
  s_sub_u32 s76, s99, s3
  s_add_u32 s99, s98, 1
  s_cmp_ge_u32 s99, 3
  s_cselect_b32 s3, 3, 0
  s_sub_u32 s77, s99, s3
  s_add_u32 s99, s98, 2
  s_cmp_ge_u32 s99, 3
  s_cselect_b32 s3, 3, 0
  s_sub_u32 s78, s99, s3
  s_add_u32 s66, s50, s76
  s_add_u32 s66, s66, 1
  s_and_b32 s66, s66, 3
  s_add_u32 s66, s66, s65
  s_mul_i32 s66, s66, 57344
  s_add_u32 s72, s66, s64
  s_add_u32 s66, s50, s77
  s_add_u32 s66, s66, 1
  s_and_b32 s66, s66, 3
  s_add_u32 s66, s66, s65
  s_mul_i32 s66, s66, 57344
  s_add_u32 s73, s66, s64
  s_add_u32 s66, s50, s78
  s_add_u32 s66, s66, 1
  s_and_b32 s66, s66, 3
  s_add_u32 s66, s66, s65
  s_mul_i32 s66, s66, 57344
  s_add_u32 s74, s66, s64
  s_mov_b32 s66, s50
  s_and_b32 s66, s66, 3
  s_add_u32 s66, s66, s65
  s_mul_i32 s66, s66, 57344
  s_add_u32 s75, s66, s64
  buffer_load_dwordx4 v[16:19], v2, s[44:47], s72 offen offset:0 sc1
  buffer_load_dwordx4 v[20:23], v2, s[44:47], s72 offen offset:1024 sc1
  buffer_load_dwordx4 v[24:27], v2, s[44:47], s72 offen offset:2048 sc1
  buffer_load_dwordx4 v[28:31], v2, s[44:47], s72 offen offset:3072 sc1
  s_add_u32 s72, s72, 4096
  buffer_load_dwordx4 v[32:35], v2, s[44:47], s72 offen offset:0 sc1
  buffer_load_dwordx4 v[36:39], v2, s[44:47], s72 offen offset:1024 sc1
  buffer_load_dwordx4 v[40:43], v2, s[44:47], s72 offen offset:2048 sc1
  buffer_load_dwordx4 v[44:47], v2, s[44:47], s72 offen offset:3072 sc1
  s_add_u32 s72, s72, 4096
  buffer_load_dwordx4 v[48:51], v2, s[44:47], s72 offen offset:0 sc1
  buffer_load_dwordx4 v[52:55], v2, s[44:47], s72 offen offset:1024 sc1
  buffer_load_dwordx4 v[56:59], v2, s[44:47], s72 offen offset:2048 sc1
  buffer_load_dwordx4 v[60:63], v2, s[44:47], s72 offen offset:3072 sc1
  v_lshlrev_b32 v14, 3, v13
  v_bfe_u32 v12, v255, 2, 2
  v_add_u32 v14, v14, v12
  v_lshlrev_b32 v14, 5, v14
  v_and_b32 v12, 3, v255
  v_lshl_add_u32 v14, v12, 3, v14
  s_lshl_b32 s66, s50, 11
  s_add_u32 s66, s66, 49152
  v_add_u32 v14, s66, v14
  ds_read_b64_tr_b16 v[240:241], v14
  ds_read_b64_tr_b16 v[242:243], v14 offset:128
  ds_read_b64_tr_b16 v[8:9], v14 offset:1024
  ds_read_b64_tr_b16 v[10:11], v14 offset:1152
  v_lshlrev_b32 v12, 4, v255
  s_mul_i32 s66, s50, 12288
  v_add_u32 v13, s66, v12
  s_waitcnt lgkmcnt(0)
  s_waitcnt vmcnt(11)
  v_mfma_f32_16x16x32_bf16 v[176:179], a[92:95], v[16:19], 0
  v_mfma_f32_16x16x32_bf16 v[180:183], a[96:99], v[16:19], 0
  v_mfma_f32_16x16x32_bf16 v[184:187], a[100:103], v[16:19], 0
  v_mfma_f32_16x16x32_bf16 v[188:191], a[104:107], v[16:19], 0
  s_add_u32 s72, s72, 4096
  buffer_load_dwordx4 v[64:67], v2, s[44:47], s72 offen offset:0 sc1
  buffer_load_dwordx4 v[68:71], v2, s[44:47], s72 offen offset:1024 sc1
  s_waitcnt vmcnt(12)
  v_mfma_f32_16x16x32_bf16 v[176:179], a[108:111], v[20:23], v[176:179]
  v_mfma_f32_16x16x32_bf16 v[180:183], a[112:115], v[20:23], v[180:183]
  v_mfma_f32_16x16x32_bf16 v[184:187], a[116:119], v[20:23], v[184:187]
  v_mfma_f32_16x16x32_bf16 v[188:191], a[120:123], v[20:23], v[188:191]
  buffer_load_dwordx4 v[72:75], v2, s[44:47], s73 offen offset:0 sc1
  buffer_load_dwordx4 v[76:79], v2, s[44:47], s73 offen offset:1024 sc1
  s_waitcnt vmcnt(13)
  v_mfma_f32_16x16x32_bf16 v[176:179], a[124:127], v[24:27], v[176:179]
  v_mfma_f32_16x16x32_bf16 v[180:183], a[128:131], v[24:27], v[180:183]
  v_mfma_f32_16x16x32_bf16 v[184:187], a[132:135], v[24:27], v[184:187]
  v_mfma_f32_16x16x32_bf16 v[188:191], a[136:139], v[24:27], v[188:191]
  buffer_load_dwordx4 v[80:83], v2, s[44:47], s73 offen offset:2048 sc1
  buffer_load_dwordx4 v[84:87], v2, s[44:47], s73 offen offset:3072 sc1
  s_waitcnt vmcnt(14)
  v_mfma_f32_16x16x32_bf16 v[176:179], a[140:143], v[28:31], v[176:179]
  v_mfma_f32_16x16x32_bf16 v[180:183], a[144:147], v[28:31], v[180:183]
  v_mfma_f32_16x16x32_bf16 v[184:187], a[148:151], v[28:31], v[184:187]
  v_mfma_f32_16x16x32_bf16 v[188:191], a[152:155], v[28:31], v[188:191]
  s_add_u32 s73, s73, 4096
  buffer_load_dwordx4 v[88:91], v2, s[44:47], s73 offen offset:0 sc1
  buffer_load_dwordx4 v[92:95], v2, s[44:47], s73 offen offset:1024 sc1
  s_waitcnt vmcnt(15)
  v_mfma_f32_16x16x32_bf16 v[176:179], a[156:159], v[32:35], v[176:179]
  v_mfma_f32_16x16x32_bf16 v[180:183], a[160:163], v[32:35], v[180:183]
  v_mfma_f32_16x16x32_bf16 v[184:187], a[164:167], v[32:35], v[184:187]
  v_mfma_f32_16x16x32_bf16 v[188:191], a[168:171], v[32:35], v[188:191]
  buffer_load_dwordx4 v[96:99], v2, s[44:47], s73 offen offset:2048 sc1
  buffer_load_dwordx4 v[100:103], v2, s[44:47], s73 offen offset:3072 sc1
  s_waitcnt vmcnt(16)
  v_mfma_f32_16x16x32_bf16 v[176:179], a[172:175], v[36:39], v[176:179]
  v_mfma_f32_16x16x32_bf16 v[180:183], a[176:179], v[36:39], v[180:183]
  v_mfma_f32_16x16x32_bf16 v[184:187], a[180:183], v[36:39], v[184:187]
  v_mfma_f32_16x16x32_bf16 v[188:191], a[184:187], v[36:39], v[188:191]
  s_add_u32 s73, s73, 4096
  buffer_load_dwordx4 v[104:107], v2, s[44:47], s73 offen offset:0 sc1
  buffer_load_dwordx4 v[108:111], v2, s[44:47], s73 offen offset:1024 sc1
  s_waitcnt vmcnt(17)
  v_mfma_f32_16x16x32_bf16 v[176:179], a[188:191], v[40:43], v[176:179]
  v_mfma_f32_16x16x32_bf16 v[180:183], a[192:195], v[40:43], v[180:183]
  v_mfma_f32_16x16x32_bf16 v[184:187], a[196:199], v[40:43], v[184:187]
  v_mfma_f32_16x16x32_bf16 v[188:191], a[200:203], v[40:43], v[188:191]
  buffer_load_dwordx4 v[112:115], v2, s[44:47], s73 offen offset:2048 sc1
  buffer_load_dwordx4 v[116:119], v2, s[44:47], s73 offen offset:3072 sc1
  s_waitcnt vmcnt(18)
  v_mfma_f32_16x16x32_bf16 v[176:179], a[204:207], v[44:47], v[176:179]
  v_mfma_f32_16x16x32_bf16 v[180:183], a[208:211], v[44:47], v[180:183]
  v_mfma_f32_16x16x32_bf16 v[184:187], a[212:215], v[44:47], v[184:187]
  v_mfma_f32_16x16x32_bf16 v[188:191], a[216:219], v[44:47], v[188:191]
  s_add_u32 s73, s73, 4096
  buffer_load_dwordx4 v[120:123], v2, s[44:47], s73 offen offset:0 sc1
  buffer_load_dwordx4 v[124:127], v2, s[44:47], s73 offen offset:1024 sc1
  s_waitcnt vmcnt(19)
  v_mfma_f32_16x16x32_bf16 v[176:179], a[220:223], v[48:51], v[176:179]
  v_mfma_f32_16x16x32_bf16 v[180:183], a[224:227], v[48:51], v[180:183]
  v_mfma_f32_16x16x32_bf16 v[184:187], a[228:231], v[48:51], v[184:187]
  v_mfma_f32_16x16x32_bf16 v[188:191], a[232:235], v[48:51], v[188:191]
  buffer_load_dwordx4 v[128:131], v2, s[44:47], s74 offen offset:0 sc1
  buffer_load_dwordx4 v[132:135], v2, s[44:47], s74 offen offset:1024 sc1
  s_waitcnt vmcnt(20)
  v_mfma_f32_16x16x32_bf16 v[176:179], a[236:239], v[52:55], v[176:179]
  v_mfma_f32_16x16x32_bf16 v[180:183], a[240:243], v[52:55], v[180:183]
  v_mfma_f32_16x16x32_bf16 v[184:187], a[244:247], v[52:55], v[184:187]
  v_mfma_f32_16x16x32_bf16 v[188:191], a[248:251], v[52:55], v[188:191]
  buffer_load_dwordx4 v[136:139], v2, s[44:47], s74 offen offset:2048 sc1
  buffer_load_dwordx4 v[140:143], v2, s[44:47], s74 offen offset:3072 sc1
  s_waitcnt vmcnt(21)
  v_mfma_f32_16x16x32_bf16 v[176:179], a[252:255], v[56:59], v[176:179]
  v_mfma_f32_16x16x32_bf16 v[180:183], a[0:3], v[56:59], v[180:183]
  v_mfma_f32_16x16x32_bf16 v[184:187], a[4:7], v[56:59], v[184:187]
  v_mfma_f32_16x16x32_bf16 v[188:191], a[8:11], v[56:59], v[188:191]
  s_add_u32 s74, s74, 4096
  buffer_load_dwordx4 v[144:147], v2, s[44:47], s74 offen offset:0 sc1
  buffer_load_dwordx4 v[148:151], v2, s[44:47], s74 offen offset:1024 sc1
  s_waitcnt vmcnt(22)
  v_mfma_f32_16x16x32_bf16 v[176:179], a[12:15], v[60:63], v[176:179]
  v_mfma_f32_16x16x32_bf16 v[180:183], a[16:19], v[60:63], v[180:183]
  v_mfma_f32_16x16x32_bf16 v[184:187], a[20:23], v[60:63], v[184:187]
  v_mfma_f32_16x16x32_bf16 v[188:191], a[24:27], v[60:63], v[188:191]
  buffer_load_dwordx4 v[152:155], v2, s[44:47], s74 offen offset:2048 sc1
  buffer_load_dwordx4 v[156:159], v2, s[44:47], s74 offen offset:3072 sc1
  s_waitcnt vmcnt(23)
  v_mfma_f32_16x16x32_bf16 v[176:179], a[28:31], v[64:67], v[176:179]
  v_mfma_f32_16x16x32_bf16 v[180:183], a[32:35], v[64:67], v[180:183]
  v_mfma_f32_16x16x32_bf16 v[184:187], a[36:39], v[64:67], v[184:187]
  v_mfma_f32_16x16x32_bf16 v[188:191], a[40:43], v[64:67], v[188:191]
  s_add_u32 s74, s74, 4096
  buffer_load_dwordx4 v[160:163], v2, s[44:47], s74 offen offset:0 sc1
  buffer_load_dwordx4 v[164:167], v2, s[44:47], s74 offen offset:1024 sc1
  s_waitcnt vmcnt(24)
  v_mfma_f32_16x16x32_bf16 v[176:179], a[44:47], v[68:71], v[176:179]
  v_mfma_f32_16x16x32_bf16 v[180:183], a[48:51], v[68:71], v[180:183]
  v_mfma_f32_16x16x32_bf16 v[184:187], a[52:55], v[68:71], v[184:187]
  v_mfma_f32_16x16x32_bf16 v[188:191], a[56:59], v[68:71], v[188:191]
  buffer_load_dwordx4 v[168:171], v2, s[44:47], s74 offen offset:2048 sc1
  buffer_load_dwordx4 v[172:175], v2, s[44:47], s74 offen offset:3072 sc1
  s_waitcnt vmcnt(25)
  v_mfma_f32_16x16x32_bf16 v[192:195], a[92:95], v[72:75], 0
  v_mfma_f32_16x16x32_bf16 v[196:199], a[96:99], v[72:75], 0
  v_mfma_f32_16x16x32_bf16 v[200:203], a[100:103], v[72:75], 0
  v_mfma_f32_16x16x32_bf16 v[204:207], a[104:107], v[72:75], 0
  s_add_u32 s74, s74, 4096
  buffer_load_dwordx4 v[16:19], v2, s[44:47], s74 offen offset:0 sc1
  buffer_load_dwordx4 v[20:23], v2, s[44:47], s74 offen offset:1024 sc1
  s_waitcnt vmcnt(26)
  v_mfma_f32_16x16x32_bf16 v[192:195], a[108:111], v[76:79], v[192:195]
  v_mfma_f32_16x16x32_bf16 v[196:199], a[112:115], v[76:79], v[196:199]
  v_mfma_f32_16x16x32_bf16 v[200:203], a[116:119], v[76:79], v[200:203]
  v_mfma_f32_16x16x32_bf16 v[204:207], a[120:123], v[76:79], v[204:207]
  buffer_load_dwordx4 v[24:27], v2, s[44:47], s75 offen offset:0 sc1
  buffer_load_dwordx4 v[28:31], v2, s[44:47], s75 offen offset:1024 sc1
  s_add_u32 s66, s50, s76
  s_add_u32 s66, s66, 1
  s_and_b32 s66, s66, 3
  s_mul_i32 s66, s66, 12288
  s_lshl_b32 s3, s76, 12
  s_add_u32 s66, s66, s3
  s_add_u32 s66, s66, 0
  v_add_u32 v14, s66, v12
  ds_write_b128 v14, v[176:179] offset:0
  ds_write_b128 v14, v[180:183] offset:1024
  ds_write_b128 v14, v[184:187] offset:2048
  ds_write_b128 v14, v[188:191] offset:3072
  s_waitcnt vmcnt(27)
  v_mfma_f32_16x16x32_bf16 v[192:195], a[124:127], v[80:83], v[192:195]
  v_mfma_f32_16x16x32_bf16 v[196:199], a[128:131], v[80:83], v[196:199]
  v_mfma_f32_16x16x32_bf16 v[200:203], a[132:135], v[80:83], v[200:203]
  v_mfma_f32_16x16x32_bf16 v[204:207], a[136:139], v[80:83], v[204:207]
  buffer_load_dwordx4 v[32:35], v2, s[44:47], s75 offen offset:2048 sc1
  s_waitcnt vmcnt(27)
  v_mfma_f32_16x16x32_bf16 v[192:195], a[140:143], v[84:87], v[192:195]
  v_mfma_f32_16x16x32_bf16 v[196:199], a[144:147], v[84:87], v[196:199]
  v_mfma_f32_16x16x32_bf16 v[200:203], a[148:151], v[84:87], v[200:203]
  v_mfma_f32_16x16x32_bf16 v[204:207], a[152:155], v[84:87], v[204:207]
  buffer_load_dwordx4 v[36:39], v2, s[44:47], s75 offen offset:3072 sc1
  s_waitcnt vmcnt(27)
  v_mfma_f32_16x16x32_bf16 v[192:195], a[156:159], v[88:91], v[192:195]
  v_mfma_f32_16x16x32_bf16 v[196:199], a[160:163], v[88:91], v[196:199]
  v_mfma_f32_16x16x32_bf16 v[200:203], a[164:167], v[88:91], v[200:203]
  v_mfma_f32_16x16x32_bf16 v[204:207], a[168:171], v[88:91], v[204:207]
  s_add_u32 s75, s75, 4096
  buffer_load_dwordx4 v[40:43], v2, s[44:47], s75 offen offset:0 sc1
  s_waitcnt vmcnt(27)
  v_mfma_f32_16x16x32_bf16 v[192:195], a[172:175], v[92:95], v[192:195]
  v_mfma_f32_16x16x32_bf16 v[196:199], a[176:179], v[92:95], v[196:199]
  v_mfma_f32_16x16x32_bf16 v[200:203], a[180:183], v[92:95], v[200:203]
  v_mfma_f32_16x16x32_bf16 v[204:207], a[184:187], v[92:95], v[204:207]
  buffer_load_dwordx4 v[44:47], v2, s[44:47], s75 offen offset:1024 sc1
  s_waitcnt vmcnt(27)
  v_mfma_f32_16x16x32_bf16 v[192:195], a[188:191], v[96:99], v[192:195]
  v_mfma_f32_16x16x32_bf16 v[196:199], a[192:195], v[96:99], v[196:199]
  v_mfma_f32_16x16x32_bf16 v[200:203], a[196:199], v[96:99], v[200:203]
  v_mfma_f32_16x16x32_bf16 v[204:207], a[200:203], v[96:99], v[204:207]
  buffer_load_dwordx4 v[48:51], v2, s[44:47], s75 offen offset:2048 sc1
  s_waitcnt vmcnt(27)
  v_mfma_f32_16x16x32_bf16 v[192:195], a[204:207], v[100:103], v[192:195]
  v_mfma_f32_16x16x32_bf16 v[196:199], a[208:211], v[100:103], v[196:199]
  v_mfma_f32_16x16x32_bf16 v[200:203], a[212:215], v[100:103], v[200:203]
  v_mfma_f32_16x16x32_bf16 v[204:207], a[216:219], v[100:103], v[204:207]
  buffer_load_dwordx4 v[52:55], v2, s[44:47], s75 offen offset:3072 sc1
  s_waitcnt vmcnt(27)
  v_mfma_f32_16x16x32_bf16 v[192:195], a[220:223], v[104:107], v[192:195]
  v_mfma_f32_16x16x32_bf16 v[196:199], a[224:227], v[104:107], v[196:199]
  v_mfma_f32_16x16x32_bf16 v[200:203], a[228:231], v[104:107], v[200:203]
  v_mfma_f32_16x16x32_bf16 v[204:207], a[232:235], v[104:107], v[204:207]
  s_add_u32 s75, s75, 4096
  buffer_load_dwordx4 v[56:59], v2, s[44:47], s75 offen offset:0 sc1
  s_waitcnt vmcnt(27)
  v_mfma_f32_16x16x32_bf16 v[192:195], a[236:239], v[108:111], v[192:195]
  v_mfma_f32_16x16x32_bf16 v[196:199], a[240:243], v[108:111], v[196:199]
  v_mfma_f32_16x16x32_bf16 v[200:203], a[244:247], v[108:111], v[200:203]
  v_mfma_f32_16x16x32_bf16 v[204:207], a[248:251], v[108:111], v[204:207]
  buffer_load_dwordx4 v[60:63], v2, s[44:47], s75 offen offset:1024 sc1
  s_waitcnt vmcnt(27)
  v_mfma_f32_16x16x32_bf16 v[192:195], a[252:255], v[112:115], v[192:195]
  v_mfma_f32_16x16x32_bf16 v[196:199], a[0:3], v[112:115], v[196:199]
  v_mfma_f32_16x16x32_bf16 v[200:203], a[4:7], v[112:115], v[200:203]
  v_mfma_f32_16x16x32_bf16 v[204:207], a[8:11], v[112:115], v[204:207]
  buffer_load_dwordx4 v[64:67], v2, s[44:47], s75 offen offset:2048 sc1
  s_waitcnt vmcnt(27)
  v_mfma_f32_16x16x32_bf16 v[192:195], a[12:15], v[116:119], v[192:195]
  v_mfma_f32_16x16x32_bf16 v[196:199], a[16:19], v[116:119], v[196:199]
  v_mfma_f32_16x16x32_bf16 v[200:203], a[20:23], v[116:119], v[200:203]
  v_mfma_f32_16x16x32_bf16 v[204:207], a[24:27], v[116:119], v[204:207]
  buffer_load_dwordx4 v[68:71], v2, s[44:47], s75 offen offset:3072 sc1
  s_waitcnt vmcnt(27)
  v_mfma_f32_16x16x32_bf16 v[192:195], a[28:31], v[120:123], v[192:195]
  v_mfma_f32_16x16x32_bf16 v[196:199], a[32:35], v[120:123], v[196:199]
  v_mfma_f32_16x16x32_bf16 v[200:203], a[36:39], v[120:123], v[200:203]
  v_mfma_f32_16x16x32_bf16 v[204:207], a[40:43], v[120:123], v[204:207]
  s_add_u32 s75, s75, 4096
  buffer_load_dwordx4 v[72:75], v2, s[44:47], s75 offen offset:0 sc1
  s_waitcnt vmcnt(27)
  v_mfma_f32_16x16x32_bf16 v[192:195], a[44:47], v[124:127], v[192:195]
  v_mfma_f32_16x16x32_bf16 v[196:199], a[48:51], v[124:127], v[196:199]
  v_mfma_f32_16x16x32_bf16 v[200:203], a[52:55], v[124:127], v[200:203]
  v_mfma_f32_16x16x32_bf16 v[204:207], a[56:59], v[124:127], v[204:207]
  buffer_load_dwordx4 v[76:79], v2, s[44:47], s75 offen offset:1024 sc1
  s_waitcnt vmcnt(27)
  v_mfma_f32_16x16x32_bf16 v[208:211], a[92:95], v[128:131], 0
  v_mfma_f32_16x16x32_bf16 v[212:215], a[96:99], v[128:131], 0
  v_mfma_f32_16x16x32_bf16 v[216:219], a[100:103], v[128:131], 0
  v_mfma_f32_16x16x32_bf16 v[220:223], a[104:107], v[128:131], 0
  s_waitcnt vmcnt(26)
  v_mfma_f32_16x16x32_bf16 v[208:211], a[108:111], v[132:135], v[208:211]
  v_mfma_f32_16x16x32_bf16 v[212:215], a[112:115], v[132:135], v[212:215]
  v_mfma_f32_16x16x32_bf16 v[216:219], a[116:119], v[132:135], v[216:219]
  v_mfma_f32_16x16x32_bf16 v[220:223], a[120:123], v[132:135], v[220:223]
  s_add_u32 s66, s50, s77
  s_add_u32 s66, s66, 1
  s_and_b32 s66, s66, 3
  s_mul_i32 s66, s66, 12288
  s_lshl_b32 s3, s77, 12
  s_add_u32 s66, s66, s3
  s_add_u32 s66, s66, 0
  v_add_u32 v14, s66, v12
  ds_write_b128 v14, v[192:195] offset:0
  ds_write_b128 v14, v[196:199] offset:1024
  ds_write_b128 v14, v[200:203] offset:2048
  ds_write_b128 v14, v[204:207] offset:3072
  s_waitcnt vmcnt(25)
  v_mfma_f32_16x16x32_bf16 v[208:211], a[124:127], v[136:139], v[208:211]
  v_mfma_f32_16x16x32_bf16 v[212:215], a[128:131], v[136:139], v[212:215]
  v_mfma_f32_16x16x32_bf16 v[216:219], a[132:135], v[136:139], v[216:219]
  v_mfma_f32_16x16x32_bf16 v[220:223], a[136:139], v[136:139], v[220:223]
  s_waitcnt vmcnt(24)
  v_mfma_f32_16x16x32_bf16 v[208:211], a[140:143], v[140:143], v[208:211]
  v_mfma_f32_16x16x32_bf16 v[212:215], a[144:147], v[140:143], v[212:215]
  v_mfma_f32_16x16x32_bf16 v[216:219], a[148:151], v[140:143], v[216:219]
  v_mfma_f32_16x16x32_bf16 v[220:223], a[152:155], v[140:143], v[220:223]
  s_waitcnt vmcnt(23)
  v_mfma_f32_16x16x32_bf16 v[208:211], a[156:159], v[144:147], v[208:211]
  v_mfma_f32_16x16x32_bf16 v[212:215], a[160:163], v[144:147], v[212:215]
  v_mfma_f32_16x16x32_bf16 v[216:219], a[164:167], v[144:147], v[216:219]
  v_mfma_f32_16x16x32_bf16 v[220:223], a[168:171], v[144:147], v[220:223]
  s_waitcnt vmcnt(22)
  v_mfma_f32_16x16x32_bf16 v[208:211], a[172:175], v[148:151], v[208:211]
  v_mfma_f32_16x16x32_bf16 v[212:215], a[176:179], v[148:151], v[212:215]
  v_mfma_f32_16x16x32_bf16 v[216:219], a[180:183], v[148:151], v[216:219]
  v_mfma_f32_16x16x32_bf16 v[220:223], a[184:187], v[148:151], v[220:223]
  s_waitcnt vmcnt(21)
  v_mfma_f32_16x16x32_bf16 v[208:211], a[188:191], v[152:155], v[208:211]
  v_mfma_f32_16x16x32_bf16 v[212:215], a[192:195], v[152:155], v[212:215]
  v_mfma_f32_16x16x32_bf16 v[216:219], a[196:199], v[152:155], v[216:219]
  v_mfma_f32_16x16x32_bf16 v[220:223], a[200:203], v[152:155], v[220:223]
  s_waitcnt vmcnt(20)
  v_mfma_f32_16x16x32_bf16 v[208:211], a[204:207], v[156:159], v[208:211]
  v_mfma_f32_16x16x32_bf16 v[212:215], a[208:211], v[156:159], v[212:215]
  v_mfma_f32_16x16x32_bf16 v[216:219], a[212:215], v[156:159], v[216:219]
  v_mfma_f32_16x16x32_bf16 v[220:223], a[216:219], v[156:159], v[220:223]
  s_waitcnt vmcnt(19)
  v_mfma_f32_16x16x32_bf16 v[208:211], a[220:223], v[160:163], v[208:211]
  v_mfma_f32_16x16x32_bf16 v[212:215], a[224:227], v[160:163], v[212:215]
  v_mfma_f32_16x16x32_bf16 v[216:219], a[228:231], v[160:163], v[216:219]
  v_mfma_f32_16x16x32_bf16 v[220:223], a[232:235], v[160:163], v[220:223]
  s_waitcnt vmcnt(18)
  v_mfma_f32_16x16x32_bf16 v[208:211], a[236:239], v[164:167], v[208:211]
  v_mfma_f32_16x16x32_bf16 v[212:215], a[240:243], v[164:167], v[212:215]
  v_mfma_f32_16x16x32_bf16 v[216:219], a[244:247], v[164:167], v[216:219]
  v_mfma_f32_16x16x32_bf16 v[220:223], a[248:251], v[164:167], v[220:223]
  s_waitcnt vmcnt(17)
  v_mfma_f32_16x16x32_bf16 v[208:211], a[252:255], v[168:171], v[208:211]
  v_mfma_f32_16x16x32_bf16 v[212:215], a[0:3], v[168:171], v[212:215]
  v_mfma_f32_16x16x32_bf16 v[216:219], a[4:7], v[168:171], v[216:219]
  v_mfma_f32_16x16x32_bf16 v[220:223], a[8:11], v[168:171], v[220:223]
  s_waitcnt vmcnt(16)
  v_mfma_f32_16x16x32_bf16 v[208:211], a[12:15], v[172:175], v[208:211]
  v_mfma_f32_16x16x32_bf16 v[212:215], a[16:19], v[172:175], v[212:215]
  v_mfma_f32_16x16x32_bf16 v[216:219], a[20:23], v[172:175], v[216:219]
  v_mfma_f32_16x16x32_bf16 v[220:223], a[24:27], v[172:175], v[220:223]
  s_waitcnt vmcnt(15)
  v_mfma_f32_16x16x32_bf16 v[208:211], a[28:31], v[16:19], v[208:211]
  v_mfma_f32_16x16x32_bf16 v[212:215], a[32:35], v[16:19], v[212:215]
  v_mfma_f32_16x16x32_bf16 v[216:219], a[36:39], v[16:19], v[216:219]
  v_mfma_f32_16x16x32_bf16 v[220:223], a[40:43], v[16:19], v[220:223]
  s_waitcnt vmcnt(14)
  v_mfma_f32_16x16x32_bf16 v[208:211], a[44:47], v[20:23], v[208:211]
  v_mfma_f32_16x16x32_bf16 v[212:215], a[48:51], v[20:23], v[212:215]
  v_mfma_f32_16x16x32_bf16 v[216:219], a[52:55], v[20:23], v[216:219]
  v_mfma_f32_16x16x32_bf16 v[220:223], a[56:59], v[20:23], v[220:223]
  s_waitcnt vmcnt(13)
  v_mfma_f32_16x16x32_bf16 v[224:227], a[92:95], v[24:27], 0
  v_mfma_f32_16x16x32_bf16 v[228:231], a[96:99], v[24:27], 0
  v_mfma_f32_16x16x32_bf16 v[232:235], a[100:103], v[24:27], 0
  v_mfma_f32_16x16x32_bf16 v[236:239], a[104:107], v[24:27], 0
  s_waitcnt vmcnt(12)
  v_mfma_f32_16x16x32_bf16 v[224:227], a[108:111], v[28:31], v[224:227]
  v_mfma_f32_16x16x32_bf16 v[228:231], a[112:115], v[28:31], v[228:231]
  v_mfma_f32_16x16x32_bf16 v[232:235], a[116:119], v[28:31], v[232:235]
  v_mfma_f32_16x16x32_bf16 v[236:239], a[120:123], v[28:31], v[236:239]
  s_add_u32 s66, s50, s78
  s_add_u32 s66, s66, 1
  s_and_b32 s66, s66, 3
  s_mul_i32 s66, s66, 12288
  s_lshl_b32 s3, s78, 12
  s_add_u32 s66, s66, s3
  s_add_u32 s66, s66, 0
  v_add_u32 v14, s66, v12
  ds_write_b128 v14, v[208:211] offset:0
  ds_write_b128 v14, v[212:215] offset:1024
  ds_write_b128 v14, v[216:219] offset:2048
  ds_write_b128 v14, v[220:223] offset:3072
  s_waitcnt vmcnt(11)
  v_mfma_f32_16x16x32_bf16 v[224:227], a[124:127], v[32:35], v[224:227]
  v_mfma_f32_16x16x32_bf16 v[228:231], a[128:131], v[32:35], v[228:231]
  v_mfma_f32_16x16x32_bf16 v[232:235], a[132:135], v[32:35], v[232:235]
  v_mfma_f32_16x16x32_bf16 v[236:239], a[136:139], v[32:35], v[236:239]
  s_waitcnt vmcnt(10)
  v_mfma_f32_16x16x32_bf16 v[224:227], a[140:143], v[36:39], v[224:227]
  v_mfma_f32_16x16x32_bf16 v[228:231], a[144:147], v[36:39], v[228:231]
  v_mfma_f32_16x16x32_bf16 v[232:235], a[148:151], v[36:39], v[232:235]
  v_mfma_f32_16x16x32_bf16 v[236:239], a[152:155], v[36:39], v[236:239]
  s_waitcnt vmcnt(9)
  v_mfma_f32_16x16x32_bf16 v[224:227], a[156:159], v[40:43], v[224:227]
  v_mfma_f32_16x16x32_bf16 v[228:231], a[160:163], v[40:43], v[228:231]
  v_mfma_f32_16x16x32_bf16 v[232:235], a[164:167], v[40:43], v[232:235]
  v_mfma_f32_16x16x32_bf16 v[236:239], a[168:171], v[40:43], v[236:239]
  s_waitcnt lgkmcnt(0)
  s_barrier
  ds_read_b128 v[176:179], v13 offset:0
  ds_read_b128 v[180:183], v13 offset:1024
  ds_read_b128 v[184:187], v13 offset:2048
  ds_read_b128 v[188:191], v13 offset:3072
  ds_read_b128 v[192:195], v13 offset:4096
  ds_read_b128 v[196:199], v13 offset:5120
  ds_read_b128 v[200:203], v13 offset:6144
  ds_read_b128 v[204:207], v13 offset:7168
  ds_read_b128 v[208:211], v13 offset:8192
  ds_read_b128 v[212:215], v13 offset:9216
  ds_read_b128 v[216:219], v13 offset:10240
  ds_read_b128 v[220:223], v13 offset:11264
  s_waitcnt vmcnt(8)
  v_mfma_f32_16x16x32_bf16 v[224:227], a[172:175], v[44:47], v[224:227]
  v_mfma_f32_16x16x32_bf16 v[228:231], a[176:179], v[44:47], v[228:231]
  v_mfma_f32_16x16x32_bf16 v[232:235], a[180:183], v[44:47], v[232:235]
  v_mfma_f32_16x16x32_bf16 v[236:239], a[184:187], v[44:47], v[236:239]
  s_waitcnt vmcnt(7)
  v_mfma_f32_16x16x32_bf16 v[224:227], a[188:191], v[48:51], v[224:227]
  v_mfma_f32_16x16x32_bf16 v[228:231], a[192:195], v[48:51], v[228:231]
  v_mfma_f32_16x16x32_bf16 v[232:235], a[196:199], v[48:51], v[232:235]
  v_mfma_f32_16x16x32_bf16 v[236:239], a[200:203], v[48:51], v[236:239]
  s_waitcnt vmcnt(6)
  v_mfma_f32_16x16x32_bf16 v[224:227], a[204:207], v[52:55], v[224:227]
  v_mfma_f32_16x16x32_bf16 v[228:231], a[208:211], v[52:55], v[228:231]
  v_mfma_f32_16x16x32_bf16 v[232:235], a[212:215], v[52:55], v[232:235]
  v_mfma_f32_16x16x32_bf16 v[236:239], a[216:219], v[52:55], v[236:239]
  s_waitcnt vmcnt(5)
  v_mfma_f32_16x16x32_bf16 v[224:227], a[220:223], v[56:59], v[224:227]
  v_mfma_f32_16x16x32_bf16 v[228:231], a[224:227], v[56:59], v[228:231]
  v_mfma_f32_16x16x32_bf16 v[232:235], a[228:231], v[56:59], v[232:235]
  v_mfma_f32_16x16x32_bf16 v[236:239], a[232:235], v[56:59], v[236:239]
  s_waitcnt vmcnt(4)
  v_mfma_f32_16x16x32_bf16 v[224:227], a[236:239], v[60:63], v[224:227]
  v_mfma_f32_16x16x32_bf16 v[228:231], a[240:243], v[60:63], v[228:231]
  v_mfma_f32_16x16x32_bf16 v[232:235], a[244:247], v[60:63], v[232:235]
  v_mfma_f32_16x16x32_bf16 v[236:239], a[248:251], v[60:63], v[236:239]
  s_waitcnt vmcnt(3)
  v_mfma_f32_16x16x32_bf16 v[224:227], a[252:255], v[64:67], v[224:227]
  v_mfma_f32_16x16x32_bf16 v[228:231], a[0:3], v[64:67], v[228:231]
  v_mfma_f32_16x16x32_bf16 v[232:235], a[4:7], v[64:67], v[232:235]
  v_mfma_f32_16x16x32_bf16 v[236:239], a[8:11], v[64:67], v[236:239]
  s_waitcnt vmcnt(2)
  v_mfma_f32_16x16x32_bf16 v[224:227], a[12:15], v[68:71], v[224:227]
  v_mfma_f32_16x16x32_bf16 v[228:231], a[16:19], v[68:71], v[228:231]
  v_mfma_f32_16x16x32_bf16 v[232:235], a[20:23], v[68:71], v[232:235]
  v_mfma_f32_16x16x32_bf16 v[236:239], a[24:27], v[68:71], v[236:239]
  s_waitcnt vmcnt(1)
  v_mfma_f32_16x16x32_bf16 v[224:227], a[28:31], v[72:75], v[224:227]
  v_mfma_f32_16x16x32_bf16 v[228:231], a[32:35], v[72:75], v[228:231]
  v_mfma_f32_16x16x32_bf16 v[232:235], a[36:39], v[72:75], v[232:235]
  v_mfma_f32_16x16x32_bf16 v[236:239], a[40:43], v[72:75], v[236:239]
  s_waitcnt vmcnt(0)
  v_mfma_f32_16x16x32_bf16 v[224:227], a[44:47], v[76:79], v[224:227]
  v_mfma_f32_16x16x32_bf16 v[228:231], a[48:51], v[76:79], v[228:231]
  v_mfma_f32_16x16x32_bf16 v[232:235], a[52:55], v[76:79], v[232:235]
  v_mfma_f32_16x16x32_bf16 v[236:239], a[56:59], v[76:79], v[236:239]
  v_mfma_f32_16x16x32_bf16 v[224:227], v[244:247], v[240:243], v[224:227]
  v_mfma_f32_16x16x32_bf16 v[228:231], v[4:7], v[240:243], v[228:231]
  v_mfma_f32_16x16x32_bf16 v[232:235], v[244:247], v[8:11], v[232:235]
  v_mfma_f32_16x16x32_bf16 v[236:239], v[4:7], v[8:11], v[236:239]
  s_waitcnt lgkmcnt(0)
  v_pk_add_f32 v[176:177], v[176:177], v[192:193]
  v_pk_add_f32 v[178:179], v[178:179], v[194:195]
  v_pk_add_f32 v[180:181], v[180:181], v[196:197]
  v_pk_add_f32 v[182:183], v[182:183], v[198:199]
  v_pk_add_f32 v[184:185], v[184:185], v[200:201]
  v_pk_add_f32 v[186:187], v[186:187], v[202:203]
  v_pk_add_f32 v[188:189], v[188:189], v[204:205]
  v_pk_add_f32 v[190:191], v[190:191], v[206:207]
  v_pk_add_f32 v[176:177], v[176:177], v[208:209]
  v_pk_add_f32 v[178:179], v[178:179], v[210:211]
  v_pk_add_f32 v[180:181], v[180:181], v[212:213]
  v_pk_add_f32 v[182:183], v[182:183], v[214:215]
  v_pk_add_f32 v[184:185], v[184:185], v[216:217]
  v_pk_add_f32 v[186:187], v[186:187], v[218:219]
  v_pk_add_f32 v[188:189], v[188:189], v[220:221]
  v_pk_add_f32 v[190:191], v[190:191], v[222:223]
  v_pk_add_f32 v[176:177], v[176:177], v[224:225]
  v_pk_add_f32 v[178:179], v[178:179], v[226:227]
  v_pk_add_f32 v[180:181], v[180:181], v[228:229]
  v_pk_add_f32 v[182:183], v[182:183], v[230:231]
  v_pk_add_f32 v[184:185], v[184:185], v[232:233]
  v_pk_add_f32 v[186:187], v[186:187], v[234:235]
  v_pk_add_f32 v[188:189], v[188:189], v[236:237]
  v_pk_add_f32 v[190:191], v[190:191], v[238:239]
  v_cvt_pk_bf16_f32 v176, v176, v177
  v_cvt_pk_bf16_f32 v177, v178, v179
  v_cvt_pk_bf16_f32 v180, v180, v181
  v_cvt_pk_bf16_f32 v181, v182, v183
  v_cvt_pk_bf16_f32 v184, v184, v185
  v_cvt_pk_bf16_f32 v185, v186, v187
  v_cvt_pk_bf16_f32 v188, v188, v189
  v_cvt_pk_bf16_f32 v189, v190, v191
  v_and_b32 v2, 15, v255
  v_lshrrev_b32 v3, 4, v255
  v_lshlrev_b32 v2, 10, v2
  v_lshl_add_u32 v2, v3, 3, v2
  s_lshl_b32 s64, s85, 16
  s_lshl_b32 s65, s50, 14
  s_add_u32 s64, s64, s65
  s_lshl_b32 s65, s86, 7
  s_add_u32 s64, s64, s65
  buffer_store_dwordx2 v[176:177], v2, s[40:43], s64 offen offset:0
  buffer_store_dwordx2 v[180:181], v2, s[40:43], s64 offen offset:32
  buffer_store_dwordx2 v[184:185], v2, s[40:43], s64 offen offset:64
  buffer_store_dwordx2 v[188:189], v2, s[40:43], s64 offen offset:96
L_end:
  s_endpgm
L_codeend:
.section .rodata,"a"
.p2align 6
.amdhsa_kernel sequential_preLN__ssm_conv_h3__glu_gated_geglu__prompt_kernel
  .amdhsa_next_free_vgpr 512
  .amdhsa_next_free_sgpr 102
  .amdhsa_accum_offset 256
  .amdhsa_group_segment_fixed_size 0
  .amdhsa_kernarg_size 104
  .amdhsa_user_sgpr_count 2
  .amdhsa_user_sgpr_kernarg_segment_ptr 1
  .amdhsa_system_sgpr_workgroup_id_x 1
.end_amdhsa_kernel
```
